```python
import torch

def _softmax(x, axis=-1):
    return torch.softmax(x, dim=axis)
def _gelu(x):
    return torch.nn.functional.gelu(x, approximate="tanh")
def _silu(x):
    return torch.nn.functional.silu(x)
def _sigmoid(x):
    return torch.sigmoid(x)
def _layernorm(x, axis=-1, eps=1e-5):
    m = x.mean(dim=axis, keepdim=True)
    v = x.var(dim=axis, keepdim=True, unbiased=False)
    return (x - m) / torch.sqrt(v + eps)
def _scatter_add(tgt, idx, src, axis=0):
    return tgt.clone().index_add_(axis, idx, src)
def _segment_sum(src, seg, n):
    out = torch.zeros((n,) + src.shape[1:], dtype=src.dtype)
    return out.index_add_(0, seg, src)
def _pad(x, pw):
    flat = tuple(v for pair in reversed(pw) for v in pair)
    return torch.nn.functional.pad(x, flat)

kernel_name = 'recurrent_scan__mha_block_cached__glu_gated_bilinear__decode'

def setup_inputs():

    _w = (lambda a: (lambda t: t.to(torch.bfloat16) if t.is_floating_point() else t)(torch.as_tensor(a)))
    def _A_setup():
        B, Sq, D = 2, 1, 640
        H, Sk, Dh = 32, 8192, 128
        return {
            "x": _w((lambda *s: torch.randn(*s, dtype=torch.bfloat16) * 0.4)(B, Sq, D)),
            "k_cache": _w((lambda *s: torch.randn(*s, dtype=torch.bfloat16) * 1.6)(B, H, Sk, Dh)),
            "v_cache": _w((lambda *s: torch.randn(*s, dtype=torch.bfloat16) * 1.6)(B, H, Sk, Dh)),
            "wq": _w((lambda *s: torch.randn(*s, dtype=torch.bfloat16) * 1.6)(D, H * Dh) * (D ** -0.5)),
            "wo": _w((lambda *s: torch.randn(*s, dtype=torch.bfloat16) * 1.6)(H * Dh, D) * ((H * Dh) ** -0.5)),
        }
    _A_in = _A_setup()

    def _B_setup():
        B, S, D, F = 2, 1, 640, 1728
        return {
            "x": _w((lambda *s: torch.randn(*s, dtype=torch.bfloat16) * 0.4)(B, S, D)),
            "w_gate": _w((lambda *s: torch.randn(*s, dtype=torch.bfloat16) * 1.6)(D, F) * (D ** -0.5)),
            "w_up": _w((lambda *s: torch.randn(*s, dtype=torch.bfloat16) * 1.6)(D, F) * (D ** -0.5)),
            "w_down": _w((lambda *s: torch.randn(*s, dtype=torch.bfloat16) * 1.6)(F, D) * (F ** -0.5)),
        }
    _B_in = _B_setup()

    return {
        "A_x": _A_in["x"],
        "A_k_cache": _A_in["k_cache"],
        "A_v_cache": _A_in["v_cache"],
        "A_wq": _A_in["wq"],
        "A_wo": _A_in["wo"],
        "B_x": _B_in["x"],
        "B_w_gate": _B_in["w_gate"],
        "B_w_up": _B_in["w_up"],
        "B_w_down": _B_in["w_down"],
    }

def reference(A_x, A_k_cache, A_v_cache, A_wq, A_wo, B_x, B_w_gate, B_w_up, B_w_down):
    def _A_ref(x, k_cache, v_cache, wq, wo):
        B, Sq, D = x.shape
        H, Dh = 32, 128
        q = (lambda x, *d: x.permute(*d))((x @ wq).reshape(B, Sq, H, Dh), 0, 2, 1, 3)
        scores = torch.einsum("bhqd,bhkd->bhqk", q, k_cache) * (Dh ** -0.5)
        p = _softmax(scores, axis=-1)
        o = torch.einsum("bhqk,bhkd->bhqd", p, v_cache)
        return (lambda x, *d: x.permute(*d))(o, 0, 2, 1, 3).reshape(B, Sq, H * Dh) @ wo

    def _B_ref(x, w_gate, w_up, w_down):
        g = torch.einsum("bsd,df->bsf", x, w_gate)
        u = torch.einsum("bsd,df->bsf", x, w_up)
        h = g * u
        return torch.einsum("bsf,fd->bsd", h, w_down)

    x = A_x
    xn = _layernorm(x, axis=-1)
    s = _A_ref(xn, A_k_cache, A_v_cache, A_wq, A_wo)
    g = _silu(_B_ref(xn, B_w_gate, B_w_up, B_w_down))
    return x + s * g
```

```asm
; @launch grid=(256,1,1) block=(320,1,1) lds=54272
.amdgcn_target "amdgcn-amd-amdhsa--gfx950"
.text
.globl recurrent_scan__mha_block_cached__glu_gated_bilinear__decode_kernel
.p2align 8
.type recurrent_scan__mha_block_cached__glu_gated_bilinear__decode_kernel,@function
recurrent_scan__mha_block_cached__glu_gated_bilinear__decode_kernel:
    s_cmp_ge_u32 s2, 256
    s_cbranch_scc1 L_end
    s_memrealtime s[68:69]
    s_load_dwordx16 s[4:19], s[0:1], 0
    s_load_dwordx8 s[20:27], s[0:1], 64
    v_lshrrev_b32 v1, 6, v0
    v_and_b32 v0, 63, v0
    v_readfirstlane_b32 s60, v1
    s_bfe_u32 s61, s2, 0x20005
    s_lshl_b32 s61, s61, 3
    s_and_b32 s64, s2, 7
    s_add_u32 s61, s61, s64
    s_lshr_b32 s63, s2, 7
    s_bfe_u32 s64, s2, 0x20003
    s_lshl2_add_u32 s62, s63, s64
    s_cmp_eq_u32 s60, 0
    s_cbranch_scc1 L_aux
    s_sub_u32 s64, s60, 1
    s_lshl_b32 s65, s63, 5
    s_add_u32 s65, s65, s61
    s_lshl_b32 s65, s65, 21
    s_and_b32 s66, s62, 3
    s_lshl_b32 s66, s66, 14
    s_lshl_b32 s67, s64, 12
    s_add_u32 s66, s66, s67
    v_lshl_add_u32 v1, v0, 4, s66
    s_mov_b32 s44, 0
    s_mov_b32 s45, 65536
    s_mov_b32 s46, 131072
    s_mov_b32 s47, 196608
    s_mov_b32 s34, 0x200000
    s_mov_b32 s35, 0x20000
    s_setprio 1
    s_waitcnt lgkmcnt(0)
    s_add_u32 s32, s6, s65
    s_addc_u32 s33, s7, 0
    s_and_b32 s33, s33, 0xffff
    buffer_load_dwordx4 v[128:131], v1, s[32:35], s44 offen offset:0 nt
    buffer_load_dwordx4 v[132:135], v1, s[32:35], s44 offen offset:1024 nt
    s_branch L_srest
L_aux:
    s_setprio 3
    v_mov_b32 v1, 0
    ds_write_b32 v1, v1 offset:4160
    ds_write_b32 v1, v1 offset:4164
    ds_write_b32 v1, v1 offset:4172
    v_lshrrev_b32 v2, 4, v0
    v_and_b32 v3, 15, v0
    v_mul_u32_u24 v6, 40, v0
    v_lshrrev_b32 v7, 3, v3
    v_mul_u32_u24 v7, 1280, v7
    v_mul_u32_u24 v8, 40, v2
    s_mul_i32 s64, s62, 160
    v_add3_u32 v7, v7, v8, s64
    s_mul_i32 s64, s62, 655360
    s_lshl_b32 s65, s61, 8
    s_add_u32 s64, s64, s65
    v_mul_u32_u24 v8, 163840, v2
    v_lshl_add_u32 v8, v3, 4, v8
    v_add_u32 v8, s64, v8
    s_mov_b32 s30, 2560
    s_mov_b32 s31, 0x20000
    s_mov_b32 s38, 5242880
    s_mov_b32 s39, 0x20000
    s_mov_b32 s70, 0
    s_waitcnt lgkmcnt(0)
    s_load_dwordx2 s[100:101], s[26:27], 0x6f000
    s_mov_b32 s28, s4
    s_and_b32 s29, s5, 0xffff
    s_mov_b32 s36, s10
    s_and_b32 s37, s11, 0xffff
    buffer_load_dwordx4 v[12:15], v6, s[28:31], 0 offen
    buffer_load_dwordx4 v[16:19], v6, s[28:31], 0 offen offset:16
    buffer_load_dwordx2 v[20:21], v6, s[28:31], 0 offen offset:32
    buffer_load_dwordx4 v[24:27], v7, s[28:31], 0 offen
    buffer_load_dwordx4 v[28:31], v7, s[28:31], 0 offen offset:16
    buffer_load_dwordx2 v[32:33], v7, s[28:31], 0 offen offset:32
    buffer_load_dwordx4 v[128:131], v8, s[36:39], s70 offen nt
    s_add_u32 s70, s70, 8192
    buffer_load_dwordx4 v[132:135], v8, s[36:39], s70 offen nt
    s_add_u32 s70, s70, 8192
    buffer_load_dwordx4 v[136:139], v8, s[36:39], s70 offen nt
    s_add_u32 s70, s70, 8192
    buffer_load_dwordx4 v[140:143], v8, s[36:39], s70 offen nt
    s_add_u32 s70, s70, 8192
    buffer_load_dwordx4 v[144:147], v8, s[36:39], s70 offen nt
    s_add_u32 s70, s70, 8192
    buffer_load_dwordx4 v[148:151], v8, s[36:39], s70 offen nt
    s_add_u32 s70, s70, 8192
    buffer_load_dwordx4 v[152:155], v8, s[36:39], s70 offen nt
    s_add_u32 s70, s70, 8192
    buffer_load_dwordx4 v[156:159], v8, s[36:39], s70 offen nt
    s_add_u32 s70, s70, 8192
    buffer_load_dwordx4 v[160:163], v8, s[36:39], s70 offen nt
    s_add_u32 s70, s70, 8192
    buffer_load_dwordx4 v[164:167], v8, s[36:39], s70 offen nt
    s_add_u32 s70, s70, 8192
    buffer_load_dwordx4 v[168:171], v8, s[36:39], s70 offen nt
    s_add_u32 s70, s70, 8192
    buffer_load_dwordx4 v[172:175], v8, s[36:39], s70 offen nt
    s_add_u32 s70, s70, 8192
    buffer_load_dwordx4 v[176:179], v8, s[36:39], s70 offen nt
    s_add_u32 s70, s70, 8192
    buffer_load_dwordx4 v[180:183], v8, s[36:39], s70 offen nt
    s_add_u32 s70, s70, 8192
    buffer_load_dwordx4 v[184:187], v8, s[36:39], s70 offen nt
    s_add_u32 s70, s70, 8192
    buffer_load_dwordx4 v[188:191], v8, s[36:39], s70 offen nt
    s_add_u32 s70, s70, 8192
    buffer_load_dwordx4 v[192:195], v8, s[36:39], s70 offen nt
    s_add_u32 s70, s70, 8192
    buffer_load_dwordx4 v[196:199], v8, s[36:39], s70 offen nt
    s_add_u32 s70, s70, 8192
    buffer_load_dwordx4 v[200:203], v8, s[36:39], s70 offen nt
    s_add_u32 s70, s70, 8192
    buffer_load_dwordx4 v[204:207], v8, s[36:39], s70 offen nt
    s_add_u32 s70, s70, 8192
    s_mov_b32 s98, 0x40000
    s_mov_b32 s99, 0x400000
    s_mov_b32 s56, s26
    s_and_b32 s57, s27, 0xffff
    s_mov_b32 s58, 0x200000
    s_mov_b32 s59, 0x20000
    v_mov_b32 v36, -1
    v_mov_b32 v37, -1
    v_mov_b32 v38, -1
    v_mov_b32 v39, -1
    s_lshl_b32 s64, s61, 3
    s_add_u32 s64, s64, s62
    s_lshl_b32 s64, s64, 9
    s_add_u32 s64, s64, 0xc0000
    v_lshlrev_b32 v9, 4, v0
    v_add_u32 v4, s64, v9
    s_mov_b32 exec_lo, 0xffffffff
    s_mov_b32 exec_hi, 0x0
    buffer_store_dwordx4 v[36:39], v4, s[56:59], 0 offen sc1
    s_getreg_b32 s52, hwreg(HW_REG_XCC_ID)
    s_lshl_b32 s64, s61, 10
    s_add_u32 s64, s64, 0x64000
    s_lshl_b32 s65, s62, 7
    s_add_u32 s65, s65, s64
    s_waitcnt lgkmcnt(0)
    s_add_u32 s100, s100, 1
    s_addc_u32 s101, s101, 0
    s_mov_b64 exec, 0xff
    v_mov_b32 v40, s52
    v_mov_b32 v41, s68
    v_mov_b32 v42, s100
    v_mov_b32 v43, s101
    buffer_store_dwordx4 v[40:43], v9, s[56:59], s65 offen sc1
    s_mov_b64 exec, -1
    v_and_b32 v5, 7, v0
    v_lshlrev_b32 v44, 10, v5
    v_lshl_add_u32 v5, v5, 7, s64
    s_and_b32 s64, s61, 7
    s_lshl_b32 s64, s64, 10
    s_sub_u32 s65, s65, s64
    v_add_u32 v44, s65, v44
    s_mov_b32 s66, 0xff00ff00
    s_mov_b32 s67, 0xff00ff00
    v_cndmask_b32 v5, v5, v44, s[66:67]
    buffer_load_dwordx4 v[104:107], v5, s[56:59], 0 offen sc1
    v_and_b32 v44, 1, v3
    v_lshlrev_b32 v44, 4, v44
    v_mov_b32 v45, 0xffff
    v_lshlrev_b32 v44, v44, v45
    v_bfe_u32 v45, v3, 1, 2
    v_cmp_eq_u32 vcc, 0, v45
    s_nop 1
    v_cndmask_b32 v48, 0, v44, vcc
    v_cmp_eq_u32 vcc, 1, v45
    s_nop 1
    v_cndmask_b32 v49, 0, v44, vcc
    v_cmp_eq_u32 vcc, 2, v45
    s_nop 1
    v_cndmask_b32 v50, 0, v44, vcc
    v_cmp_eq_u32 vcc, 3, v45
    s_nop 1
    v_cndmask_b32 v51, 0, v44, vcc
    s_lshl_b32 s64, s61, 14
    s_add_u32 s64, s64, 0xe0000
    s_lshl_b32 s65, s62, 10
    s_add_u32 s65, s65, s64
    v_lshrrev_b32 v10, 1, v2
    v_lshlrev_b32 v10, 13, v10
    v_lshl_add_u32 v10, v3, 5, v10
    v_and_b32 v11, 1, v2
    v_lshl_add_u32 v10, v11, 4, v10
    v_add_u32 v10, s65, v10
    s_lshl_b32 s65, s63, 13
    s_add_u32 s64, s64, s65
    v_lshlrev_b32 v11, 4, v0
    v_add_u32 v11, s64, v11
    s_mov_b32 s64, 0xff00ff00
    s_mov_b32 s65, 0xff00ff00
    s_waitcnt vmcnt(26)
    v_lshlrev_b32 v60, 16, v12
    v_and_b32 v61, 0xffff0000, v12
    v_lshlrev_b32 v62, 16, v13
    v_and_b32 v63, 0xffff0000, v13
    v_lshlrev_b32 v64, 16, v14
    v_and_b32 v65, 0xffff0000, v14
    v_lshlrev_b32 v66, 16, v15
    v_and_b32 v67, 0xffff0000, v15
    v_lshlrev_b32 v68, 16, v16
    v_and_b32 v69, 0xffff0000, v16
    v_lshlrev_b32 v70, 16, v17
    v_and_b32 v71, 0xffff0000, v17
    v_lshlrev_b32 v72, 16, v18
    v_and_b32 v73, 0xffff0000, v18
    v_lshlrev_b32 v74, 16, v19
    v_and_b32 v75, 0xffff0000, v19
    v_lshlrev_b32 v76, 16, v20
    v_and_b32 v77, 0xffff0000, v20
    v_lshlrev_b32 v78, 16, v21
    v_and_b32 v79, 0xffff0000, v21
    v_add_f32 v52, v60, v61
    v_add_f32 v53, v62, v63
    v_add_f32 v52, v52, v64
    v_add_f32 v53, v53, v65
    v_add_f32 v52, v52, v66
    v_add_f32 v53, v53, v67
    v_add_f32 v52, v52, v68
    v_add_f32 v53, v53, v69
    v_add_f32 v52, v52, v70
    v_add_f32 v53, v53, v71
    v_add_f32 v52, v52, v72
    v_add_f32 v53, v53, v73
    v_add_f32 v52, v52, v74
    v_add_f32 v53, v53, v75
    v_add_f32 v52, v52, v76
    v_add_f32 v53, v53, v77
    v_add_f32 v52, v52, v78
    v_add_f32 v53, v53, v79
    v_add_f32 v52, v52, v53
    s_nop 1
    v_add_f32_dpp v52, v52, v52 row_ror:8 row_mask:0xf bank_mask:0xf
    s_nop 1
    v_add_f32_dpp v52, v52, v52 row_ror:4 row_mask:0xf bank_mask:0xf
    s_nop 1
    v_add_f32_dpp v52, v52, v52 row_ror:2 row_mask:0xf bank_mask:0xf
    s_nop 1
    v_add_f32_dpp v52, v52, v52 row_ror:1 row_mask:0xf bank_mask:0xf
    v_mov_b32 v54, v52
    s_nop 1
    v_permlane16_swap_b32 v52, v54
    s_nop 0
    v_add_f32 v52, v52, v54
    v_mul_f32 v52, 0x3acccccd, v52
    v_sub_f32 v60, v60, v52
    v_sub_f32 v61, v61, v52
    v_sub_f32 v62, v62, v52
    v_sub_f32 v63, v63, v52
    v_sub_f32 v64, v64, v52
    v_sub_f32 v65, v65, v52
    v_sub_f32 v66, v66, v52
    v_sub_f32 v67, v67, v52
    v_sub_f32 v68, v68, v52
    v_sub_f32 v69, v69, v52
    v_sub_f32 v70, v70, v52
    v_sub_f32 v71, v71, v52
    v_sub_f32 v72, v72, v52
    v_sub_f32 v73, v73, v52
    v_sub_f32 v74, v74, v52
    v_sub_f32 v75, v75, v52
    v_sub_f32 v76, v76, v52
    v_sub_f32 v77, v77, v52
    v_sub_f32 v78, v78, v52
    v_sub_f32 v79, v79, v52
    v_mul_f32 v53, v60, v60
    v_mul_f32 v54, v61, v61
    v_fmac_f32 v53, v62, v62
    v_fmac_f32 v54, v63, v63
    v_fmac_f32 v53, v64, v64
    v_fmac_f32 v54, v65, v65
    v_fmac_f32 v53, v66, v66
    v_fmac_f32 v54, v67, v67
    v_fmac_f32 v53, v68, v68
    v_fmac_f32 v54, v69, v69
    v_fmac_f32 v53, v70, v70
    v_fmac_f32 v54, v71, v71
    v_fmac_f32 v53, v72, v72
    v_fmac_f32 v54, v73, v73
    v_fmac_f32 v53, v74, v74
    v_fmac_f32 v54, v75, v75
    v_fmac_f32 v53, v76, v76
    v_fmac_f32 v54, v77, v77
    v_fmac_f32 v53, v78, v78
    v_fmac_f32 v54, v79, v79
    v_add_f32 v53, v53, v54
    s_nop 1
    v_add_f32_dpp v53, v53, v53 row_ror:8 row_mask:0xf bank_mask:0xf
    s_nop 1
    v_add_f32_dpp v53, v53, v53 row_ror:4 row_mask:0xf bank_mask:0xf
    s_nop 1
    v_add_f32_dpp v53, v53, v53 row_ror:2 row_mask:0xf bank_mask:0xf
    s_nop 1
    v_add_f32_dpp v53, v53, v53 row_ror:1 row_mask:0xf bank_mask:0xf
    v_mov_b32 v54, v53
    s_nop 1
    v_permlane16_swap_b32 v53, v54
    s_nop 0
    v_add_f32 v53, v53, v54
    v_mul_f32 v53, 0x3acccccd, v53
    v_cvt_pk_bf16_f32 v52, v52, v52
    v_and_b32 v52, 0xffff0000, v52
    v_cvt_pk_bf16_f32 v53, v53, v53
    v_and_b32 v53, 0xffff0000, v53
    v_add_f32 v53, 0x3727c5ac, v53
    v_cvt_pk_bf16_f32 v53, v53, v53
    v_and_b32 v53, 0xffff0000, v53
    v_sqrt_f32 v53, v53
    s_nop 0
    v_cvt_pk_bf16_f32 v53, v53, v53
    v_and_b32 v53, 0xffff0000, v53
    v_rcp_f32 v53, v53
    v_readlane_b32 s44, v52, 0
    v_readlane_b32 s46, v52, 32
    v_readlane_b32 s45, v53, 0
    v_readlane_b32 s47, v53, 32
    s_waitcnt vmcnt(23)
    v_lshlrev_b32 v60, 16, v24
    v_and_b32 v61, 0xffff0000, v24
    v_lshlrev_b32 v62, 16, v25
    v_and_b32 v63, 0xffff0000, v25
    v_lshlrev_b32 v64, 16, v26
    v_and_b32 v65, 0xffff0000, v26
    v_lshlrev_b32 v66, 16, v27
    v_and_b32 v67, 0xffff0000, v27
    v_lshlrev_b32 v68, 16, v28
    v_and_b32 v69, 0xffff0000, v28
    v_lshlrev_b32 v70, 16, v29
    v_and_b32 v71, 0xffff0000, v29
    v_lshlrev_b32 v72, 16, v30
    v_and_b32 v73, 0xffff0000, v30
    v_lshlrev_b32 v74, 16, v31
    v_and_b32 v75, 0xffff0000, v31
    v_lshlrev_b32 v76, 16, v32
    v_and_b32 v77, 0xffff0000, v32
    v_lshlrev_b32 v78, 16, v33
    v_and_b32 v79, 0xffff0000, v33
    v_mov_b32 v52, s44
    v_mov_b32 v53, s45
    v_mov_b32 v54, s46
    v_mov_b32 v55, s47
    v_cndmask_b32 v52, v52, v54, s[64:65]
    v_cndmask_b32 v53, v53, v55, s[64:65]
    v_sub_f32 v60, v60, v52
    v_sub_f32 v61, v61, v52
    v_sub_f32 v62, v62, v52
    v_sub_f32 v63, v63, v52
    v_sub_f32 v64, v64, v52
    v_sub_f32 v65, v65, v52
    v_sub_f32 v66, v66, v52
    v_sub_f32 v67, v67, v52
    v_sub_f32 v68, v68, v52
    v_sub_f32 v69, v69, v52
    v_sub_f32 v70, v70, v52
    v_sub_f32 v71, v71, v52
    v_sub_f32 v72, v72, v52
    v_sub_f32 v73, v73, v52
    v_sub_f32 v74, v74, v52
    v_sub_f32 v75, v75, v52
    v_sub_f32 v76, v76, v52
    v_sub_f32 v77, v77, v52
    v_sub_f32 v78, v78, v52
    v_sub_f32 v79, v79, v52
    v_cvt_pk_bf16_f32 v60, v60, v60
    v_and_b32 v60, 0xffff0000, v60
    v_cvt_pk_bf16_f32 v61, v61, v61
    v_and_b32 v61, 0xffff0000, v61
    v_cvt_pk_bf16_f32 v62, v62, v62
    v_and_b32 v62, 0xffff0000, v62
    v_cvt_pk_bf16_f32 v63, v63, v63
    v_and_b32 v63, 0xffff0000, v63
    v_cvt_pk_bf16_f32 v64, v64, v64
    v_and_b32 v64, 0xffff0000, v64
    v_cvt_pk_bf16_f32 v65, v65, v65
    v_and_b32 v65, 0xffff0000, v65
    v_cvt_pk_bf16_f32 v66, v66, v66
    v_and_b32 v66, 0xffff0000, v66
    v_cvt_pk_bf16_f32 v67, v67, v67
    v_and_b32 v67, 0xffff0000, v67
    v_cvt_pk_bf16_f32 v68, v68, v68
    v_and_b32 v68, 0xffff0000, v68
    v_cvt_pk_bf16_f32 v69, v69, v69
    v_and_b32 v69, 0xffff0000, v69
    v_cvt_pk_bf16_f32 v70, v70, v70
    v_and_b32 v70, 0xffff0000, v70
    v_cvt_pk_bf16_f32 v71, v71, v71
    v_and_b32 v71, 0xffff0000, v71
    v_cvt_pk_bf16_f32 v72, v72, v72
    v_and_b32 v72, 0xffff0000, v72
    v_cvt_pk_bf16_f32 v73, v73, v73
    v_and_b32 v73, 0xffff0000, v73
    v_cvt_pk_bf16_f32 v74, v74, v74
    v_and_b32 v74, 0xffff0000, v74
    v_cvt_pk_bf16_f32 v75, v75, v75
    v_and_b32 v75, 0xffff0000, v75
    v_cvt_pk_bf16_f32 v76, v76, v76
    v_and_b32 v76, 0xffff0000, v76
    v_cvt_pk_bf16_f32 v77, v77, v77
    v_and_b32 v77, 0xffff0000, v77
    v_cvt_pk_bf16_f32 v78, v78, v78
    v_and_b32 v78, 0xffff0000, v78
    v_cvt_pk_bf16_f32 v79, v79, v79
    v_and_b32 v79, 0xffff0000, v79
    v_mul_f32 v60, v60, v53
    v_mul_f32 v61, v61, v53
    v_mul_f32 v62, v62, v53
    v_mul_f32 v63, v63, v53
    v_mul_f32 v64, v64, v53
    v_mul_f32 v65, v65, v53
    v_mul_f32 v66, v66, v53
    v_mul_f32 v67, v67, v53
    v_mul_f32 v68, v68, v53
    v_mul_f32 v69, v69, v53
    v_mul_f32 v70, v70, v53
    v_mul_f32 v71, v71, v53
    v_mul_f32 v72, v72, v53
    v_mul_f32 v73, v73, v53
    v_mul_f32 v74, v74, v53
    v_mul_f32 v75, v75, v53
    v_mul_f32 v76, v76, v53
    v_mul_f32 v77, v77, v53
    v_mul_f32 v78, v78, v53
    v_mul_f32 v79, v79, v53
    v_cvt_pk_bf16_f32 v60, v60, v60
    v_cvt_pk_bf16_f32 v61, v61, v61
    v_cvt_pk_bf16_f32 v62, v62, v62
    v_cvt_pk_bf16_f32 v63, v63, v63
    v_cvt_pk_bf16_f32 v64, v64, v64
    v_cvt_pk_bf16_f32 v65, v65, v65
    v_cvt_pk_bf16_f32 v66, v66, v66
    v_cvt_pk_bf16_f32 v67, v67, v67
    v_cvt_pk_bf16_f32 v68, v68, v68
    v_cvt_pk_bf16_f32 v69, v69, v69
    v_cvt_pk_bf16_f32 v70, v70, v70
    v_cvt_pk_bf16_f32 v71, v71, v71
    v_cvt_pk_bf16_f32 v72, v72, v72
    v_cvt_pk_bf16_f32 v73, v73, v73
    v_cvt_pk_bf16_f32 v74, v74, v74
    v_cvt_pk_bf16_f32 v75, v75, v75
    v_cvt_pk_bf16_f32 v76, v76, v76
    v_cvt_pk_bf16_f32 v77, v77, v77
    v_cvt_pk_bf16_f32 v78, v78, v78
    v_cvt_pk_bf16_f32 v79, v79, v79
    buffer_load_dwordx4 v[108:111], v5, s[56:59], 0 offen sc1
    v_and_b32 v112, v60, v48
    v_and_b32 v113, v60, v49
    v_and_b32 v114, v60, v50
    v_and_b32 v115, v60, v51
    s_waitcnt vmcnt(23)
    s_nop 0
    v_mfma_f32_16x16x32_bf16 v[96:99], v[112:115], v[128:131], 0
    v_and_b32 v116, v61, v48
    v_and_b32 v117, v61, v49
    v_and_b32 v118, v61, v50
    v_and_b32 v119, v61, v51
    s_waitcnt vmcnt(22)
    s_nop 0
    v_mfma_f32_16x16x32_bf16 v[96:99], v[116:119], v[132:135], v[96:99]
    v_and_b32 v112, v62, v48
    v_and_b32 v113, v62, v49
    v_and_b32 v114, v62, v50
    v_and_b32 v115, v62, v51
    s_waitcnt vmcnt(21)
    s_nop 0
    v_mfma_f32_16x16x32_bf16 v[96:99], v[112:115], v[136:139], v[96:99]
    v_and_b32 v116, v63, v48
    v_and_b32 v117, v63, v49
    v_and_b32 v118, v63, v50
    v_and_b32 v119, v63, v51
    s_waitcnt vmcnt(20)
    s_nop 0
    v_mfma_f32_16x16x32_bf16 v[96:99], v[116:119], v[140:143], v[96:99]
    v_and_b32 v112, v64, v48
    v_and_b32 v113, v64, v49
    v_and_b32 v114, v64, v50
    v_and_b32 v115, v64, v51
    s_waitcnt vmcnt(19)
    s_nop 0
    v_mfma_f32_16x16x32_bf16 v[96:99], v[112:115], v[144:147], v[96:99]
    v_and_b32 v116, v65, v48
    v_and_b32 v117, v65, v49
    v_and_b32 v118, v65, v50
    v_and_b32 v119, v65, v51
    s_waitcnt vmcnt(18)
    s_nop 0
    v_mfma_f32_16x16x32_bf16 v[96:99], v[116:119], v[148:151], v[96:99]
    v_and_b32 v112, v66, v48
    v_and_b32 v113, v66, v49
    v_and_b32 v114, v66, v50
    v_and_b32 v115, v66, v51
    s_waitcnt vmcnt(17)
    s_nop 0
    v_mfma_f32_16x16x32_bf16 v[96:99], v[112:115], v[152:155], v[96:99]
    v_and_b32 v116, v67, v48
    v_and_b32 v117, v67, v49
    v_and_b32 v118, v67, v50
    v_and_b32 v119, v67, v51
    s_waitcnt vmcnt(16)
    s_nop 0
    v_mfma_f32_16x16x32_bf16 v[96:99], v[116:119], v[156:159], v[96:99]
    v_and_b32 v112, v68, v48
    v_and_b32 v113, v68, v49
    v_and_b32 v114, v68, v50
    v_and_b32 v115, v68, v51
    s_waitcnt vmcnt(15)
    s_nop 0
    v_mfma_f32_16x16x32_bf16 v[96:99], v[112:115], v[160:163], v[96:99]
    v_and_b32 v116, v69, v48
    v_and_b32 v117, v69, v49
    v_and_b32 v118, v69, v50
    v_and_b32 v119, v69, v51
    s_waitcnt vmcnt(14)
    s_nop 0
    v_mfma_f32_16x16x32_bf16 v[96:99], v[116:119], v[164:167], v[96:99]
    v_and_b32 v112, v70, v48
    v_and_b32 v113, v70, v49
    v_and_b32 v114, v70, v50
    v_and_b32 v115, v70, v51
    s_waitcnt vmcnt(13)
    s_nop 0
    v_mfma_f32_16x16x32_bf16 v[96:99], v[112:115], v[168:171], v[96:99]
    v_and_b32 v116, v71, v48
    v_and_b32 v117, v71, v49
    v_and_b32 v118, v71, v50
    v_and_b32 v119, v71, v51
    s_waitcnt vmcnt(12)
    s_nop 0
    v_mfma_f32_16x16x32_bf16 v[96:99], v[116:119], v[172:175], v[96:99]
    v_and_b32 v112, v72, v48
    v_and_b32 v113, v72, v49
    v_and_b32 v114, v72, v50
    v_and_b32 v115, v72, v51
    s_waitcnt vmcnt(11)
    s_nop 0
    v_mfma_f32_16x16x32_bf16 v[96:99], v[112:115], v[176:179], v[96:99]
    v_and_b32 v116, v73, v48
    v_and_b32 v117, v73, v49
    v_and_b32 v118, v73, v50
    v_and_b32 v119, v73, v51
    s_waitcnt vmcnt(10)
    s_nop 0
    v_mfma_f32_16x16x32_bf16 v[96:99], v[116:119], v[180:183], v[96:99]
    v_and_b32 v112, v74, v48
    v_and_b32 v113, v74, v49
    v_and_b32 v114, v74, v50
    v_and_b32 v115, v74, v51
    s_waitcnt vmcnt(9)
    s_nop 0
    v_mfma_f32_16x16x32_bf16 v[96:99], v[112:115], v[184:187], v[96:99]
    v_and_b32 v116, v75, v48
    v_and_b32 v117, v75, v49
    v_and_b32 v118, v75, v50
    v_and_b32 v119, v75, v51
    s_waitcnt vmcnt(8)
    s_nop 0
    v_mfma_f32_16x16x32_bf16 v[96:99], v[116:119], v[188:191], v[96:99]
    v_and_b32 v112, v76, v48
    v_and_b32 v113, v76, v49
    v_and_b32 v114, v76, v50
    v_and_b32 v115, v76, v51
    s_waitcnt vmcnt(7)
    s_nop 0
    v_mfma_f32_16x16x32_bf16 v[96:99], v[112:115], v[192:195], v[96:99]
    v_and_b32 v116, v77, v48
    v_and_b32 v117, v77, v49
    v_and_b32 v118, v77, v50
    v_and_b32 v119, v77, v51
    s_waitcnt vmcnt(6)
    s_nop 0
    v_mfma_f32_16x16x32_bf16 v[96:99], v[116:119], v[196:199], v[96:99]
    v_and_b32 v112, v78, v48
    v_and_b32 v113, v78, v49
    v_and_b32 v114, v78, v50
    v_and_b32 v115, v78, v51
    s_waitcnt vmcnt(5)
    s_nop 0
    v_mfma_f32_16x16x32_bf16 v[96:99], v[112:115], v[200:203], v[96:99]
    v_and_b32 v116, v79, v48
    v_and_b32 v117, v79, v49
    v_and_b32 v118, v79, v50
    v_and_b32 v119, v79, v51
    s_waitcnt vmcnt(4)
    s_nop 0
    v_mfma_f32_16x16x32_bf16 v[96:99], v[116:119], v[204:207], v[96:99]
    v_mov_b32 v102, s100
    v_mov_b32 v103, s101
    s_waitcnt vmcnt(1)
    v_cmp_ne_u64 s[70:71], s[100:101], v[106:107]
    s_andn2_b64 vcc, s[70:71], s[66:67]
    s_cbranch_vccz L_pollX_ok
L_pollX:
    s_waitcnt vmcnt(0)
    v_mov_b32 v104, v108
    v_mov_b32 v105, v109
    v_cmp_ne_u64 s[70:71], s[100:101], v[110:111]
    s_andn2_b64 vcc, s[70:71], s[66:67]
    s_cbranch_vccz L_pollX_ok
    buffer_load_dwordx4 v[108:111], v5, s[56:59], 0 offen sc1
    s_sub_u32 s98, s98, 1
    s_cbranch_scc0 L_pollX
L_pollX_ok:
    v_cmp_ne_u32 vcc, s52, v104
    v_subrev_u32 v92, s68, v105
    v_cndmask_b32 v92, v92, 0, s[70:71]
    v_mov_b32 v100, v96
    v_mov_b32 v101, v97
    v_mov_b32 v104, v98
    v_mov_b32 v105, v99
    v_mov_b32 v106, s100
    v_mov_b32 v107, s101
    s_andn2_b64 vcc, vcc, s[66:67]
    s_cselect_b32 s97, 0, 1
    s_cmp_eq_u32 s97, 0
    s_cbranch_scc1 L_far_q
    buffer_store_dwordx4 v[100:103], v10, s[56:59], 0 offen
    buffer_store_dwordx4 v[104:107], v10, s[56:59], 0 offen offset:512
L_near_q:
    s_nop 1
    v_add_u32_dpp v92, v92, v92 row_ror:8 row_mask:0xf bank_mask:0xf
    s_nop 1
    v_add_u32_dpp v92, v92, v92 row_ror:4 row_mask:0xf bank_mask:0xf
    s_nop 1
    v_add_u32_dpp v92, v92, v92 row_ror:2 row_mask:0xf bank_mask:0xf
    s_nop 1
    v_add_u32_dpp v92, v92, v92 row_ror:1 row_mask:0xf bank_mask:0xf
    v_ashrrev_i32 v92, 4, v92
    s_mov_b32 s70, 4096
    v_and_b32 v6, 31, v0
    v_lshlrev_b32 v6, 3, v6
    v_lshrrev_b32 v7, 5, v0
    v_lshl_add_u32 v6, v7, 2, v6
    s_waitcnt vmcnt(0)
L_pollQ:
    buffer_load_dwordx4 v[128:131], v11, s[56:59], 0 offen offset:0 sc1
    buffer_load_dwordx4 v[132:135], v11, s[56:59], 0 offen offset:1024 sc1
    buffer_load_dwordx4 v[136:139], v11, s[56:59], 0 offen offset:2048 sc1
    buffer_load_dwordx4 v[140:143], v11, s[56:59], 0 offen offset:3072 sc1
    buffer_load_dwordx4 v[144:147], v11, s[56:59], s70 offen offset:0 sc1
    buffer_load_dwordx4 v[148:151], v11, s[56:59], s70 offen offset:1024 sc1
    buffer_load_dwordx4 v[152:155], v11, s[56:59], s70 offen offset:2048 sc1
    buffer_load_dwordx4 v[156:159], v11, s[56:59], s70 offen offset:3072 sc1
    s_waitcnt vmcnt(0)
    v_cmp_ne_u64 vcc, s[100:101], v[130:131]
    v_cmp_ne_u64 s[66:67], s[100:101], v[134:135]
    s_or_b64 vcc, vcc, s[66:67]
    v_cmp_ne_u64 s[66:67], s[100:101], v[138:139]
    s_or_b64 vcc, vcc, s[66:67]
    v_cmp_ne_u64 s[66:67], s[100:101], v[142:143]
    s_or_b64 vcc, vcc, s[66:67]
    v_cmp_ne_u64 s[66:67], s[100:101], v[146:147]
    s_or_b64 vcc, vcc, s[66:67]
    v_cmp_ne_u64 s[66:67], s[100:101], v[150:151]
    s_or_b64 vcc, vcc, s[66:67]
    v_cmp_ne_u64 s[66:67], s[100:101], v[154:155]
    s_or_b64 vcc, vcc, s[66:67]
    v_cmp_ne_u64 s[66:67], s[100:101], v[158:159]
    s_or_b64 vcc, vcc, s[66:67]
    s_cbranch_vccz L_pollQ_0
    s_sleep 1
    s_sub_u32 s98, s98, 1
    s_cbranch_scc0 L_pollQ
L_pollQ_0:
    v_add_f32 v128, v128, v144
    v_add_f32 v129, v129, v145
    v_add_f32 v132, v132, v148
    v_add_f32 v133, v133, v149
    v_add_f32 v136, v136, v152
    v_add_f32 v137, v137, v153
    v_add_f32 v140, v140, v156
    v_add_f32 v141, v141, v157
    v_add_f32 v128, v128, v136
    v_add_f32 v129, v129, v137
    v_add_f32 v132, v132, v140
    v_add_f32 v133, v133, v141
    v_add_f32 v96, v128, v132
    v_add_f32 v97, v129, v133
L_pollQ_ok:
    v_cvt_pk_bf16_f32 v96, v96, v97
    ds_write_b32 v6, v96 offset:0
    ds_write_b32 v1, v92 offset:4168
    s_waitcnt lgkmcnt(0)
    s_barrier
    s_setprio 0
    s_waitcnt vmcnt(0)
    s_mov_b32 s32, s16
    s_and_b32 s33, s17, 0xffff
    s_mov_b32 s34, 0x21c000
    s_mov_b32 s35, 0x20000
    s_mov_b32 s36, s18
    s_and_b32 s37, s19, 0xffff
    s_mov_b32 s38, 0x21c000
    s_mov_b32 s39, 0x20000
    s_mov_b32 s40, s12
    s_and_b32 s41, s13, 0xffff
    s_mov_b32 s42, 0x500000
    s_mov_b32 s43, 0x20000
    s_mov_b32 s48, s22
    s_and_b32 s49, s23, 0xffff
    s_mov_b32 s50, 0xa00
    s_mov_b32 s51, 0x20000
    s_and_b32 s64, s61, 7
    s_mul_i32 s64, s64, 27
    s_add_u32 s65, s64, 31
    s_add_u32 s64, s64, 4
    s_lshr_b32 s64, s64, 3
    s_lshr_b32 s65, s65, 3
    s_sub_u32 s68, s65, s64
    s_lshr_b32 s65, s61, 3
    s_mul_i32 s65, s65, s68
    s_lshl2_add_u32 s55, s64, s65
    s_lshl_b32 s55, s55, 4
    v_lshrrev_b32 v7, 3, v0
    v_mul_u32_u24 v6, 20, v7
    s_mul_i32 s70, s62, 160
    v_add_u32 v6, s70, v6
    buffer_load_dwordx4 v[28:31], v6, s[28:31], 0 offen
    buffer_load_dword v32, v6, s[28:31], 0 offen offset:16
    buffer_load_dwordx4 v[36:39], v6, s[28:31], 0 offen offset:1280
    buffer_load_dword v40, v6, s[28:31], 0 offen offset:1296
    v_mul_u32_u24 v6, 34560, v7
    v_and_b32 v7, 7, v0
    s_lshl_b32 s71, s68, 1
    s_sub_u32 s71, s71, 1
    v_min_u32 v7, s71, v7
    v_lshl_add_u32 v6, v7, 4, v6
    s_mul_i32 s70, s62, 276480
    s_lshl_b32 s71, s55, 1
    s_add_u32 s70, s70, s71
    v_add_u32 v6, s70, v6
    s_mov_b32 s70, 0
    buffer_load_dwordx4 v[128:131], v6, s[32:35], s70 offen
    buffer_load_dwordx4 v[168:171], v6, s[36:39], s70 offen
    s_add_u32 s70, s70, 3456
    buffer_load_dwordx4 v[132:135], v6, s[32:35], s70 offen
    buffer_load_dwordx4 v[172:175], v6, s[36:39], s70 offen
    s_add_u32 s70, s70, 3456
    buffer_load_dwordx4 v[136:139], v6, s[32:35], s70 offen
    buffer_load_dwordx4 v[176:179], v6, s[36:39], s70 offen
    s_add_u32 s70, s70, 3456
    buffer_load_dwordx4 v[140:143], v6, s[32:35], s70 offen
    buffer_load_dwordx4 v[180:183], v6, s[36:39], s70 offen
    s_add_u32 s70, s70, 3456
    buffer_load_dwordx4 v[144:147], v6, s[32:35], s70 offen
    buffer_load_dwordx4 v[184:187], v6, s[36:39], s70 offen
    s_add_u32 s70, s70, 3456
    buffer_load_dwordx4 v[148:151], v6, s[32:35], s70 offen
    buffer_load_dwordx4 v[188:191], v6, s[36:39], s70 offen
    s_add_u32 s70, s70, 3456
    buffer_load_dwordx4 v[152:155], v6, s[32:35], s70 offen
    buffer_load_dwordx4 v[192:195], v6, s[36:39], s70 offen
    s_add_u32 s70, s70, 3456
    buffer_load_dwordx4 v[156:159], v6, s[32:35], s70 offen
    buffer_load_dwordx4 v[196:199], v6, s[36:39], s70 offen
    s_add_u32 s70, s70, 3456
    buffer_load_dwordx4 v[160:163], v6, s[32:35], s70 offen
    buffer_load_dwordx4 v[200:203], v6, s[36:39], s70 offen
    s_add_u32 s70, s70, 3456
    buffer_load_dwordx4 v[164:167], v6, s[32:35], s70 offen
    buffer_load_dwordx4 v[204:207], v6, s[36:39], s70 offen
    s_add_u32 s70, s70, 3456
    s_waitcnt vmcnt(20)
    v_lshlrev_b32 v60, 16, v28
    v_and_b32 v61, 0xffff0000, v28
    v_lshlrev_b32 v62, 16, v29
    v_and_b32 v63, 0xffff0000, v29
    v_lshlrev_b32 v64, 16, v30
    v_and_b32 v65, 0xffff0000, v30
    v_lshlrev_b32 v66, 16, v31
    v_and_b32 v67, 0xffff0000, v31
    v_lshlrev_b32 v68, 16, v32
    v_and_b32 v69, 0xffff0000, v32
    v_mov_b32 v52, s44
    v_mov_b32 v53, s45
    v_sub_f32 v60, v60, v52
    v_sub_f32 v61, v61, v52
    v_sub_f32 v62, v62, v52
    v_sub_f32 v63, v63, v52
    v_sub_f32 v64, v64, v52
    v_sub_f32 v65, v65, v52
    v_sub_f32 v66, v66, v52
    v_sub_f32 v67, v67, v52
    v_sub_f32 v68, v68, v52
    v_sub_f32 v69, v69, v52
    v_cvt_pk_bf16_f32 v60, v60, v60
    v_and_b32 v60, 0xffff0000, v60
    v_cvt_pk_bf16_f32 v61, v61, v61
    v_and_b32 v61, 0xffff0000, v61
    v_cvt_pk_bf16_f32 v62, v62, v62
    v_and_b32 v62, 0xffff0000, v62
    v_cvt_pk_bf16_f32 v63, v63, v63
    v_and_b32 v63, 0xffff0000, v63
    v_cvt_pk_bf16_f32 v64, v64, v64
    v_and_b32 v64, 0xffff0000, v64
    v_cvt_pk_bf16_f32 v65, v65, v65
    v_and_b32 v65, 0xffff0000, v65
    v_cvt_pk_bf16_f32 v66, v66, v66
    v_and_b32 v66, 0xffff0000, v66
    v_cvt_pk_bf16_f32 v67, v67, v67
    v_and_b32 v67, 0xffff0000, v67
    v_cvt_pk_bf16_f32 v68, v68, v68
    v_and_b32 v68, 0xffff0000, v68
    v_cvt_pk_bf16_f32 v69, v69, v69
    v_and_b32 v69, 0xffff0000, v69
    v_mul_f32 v60, v60, v53
    v_mul_f32 v61, v61, v53
    v_mul_f32 v62, v62, v53
    v_mul_f32 v63, v63, v53
    v_mul_f32 v64, v64, v53
    v_mul_f32 v65, v65, v53
    v_mul_f32 v66, v66, v53
    v_mul_f32 v67, v67, v53
    v_mul_f32 v68, v68, v53
    v_mul_f32 v69, v69, v53
    v_cvt_pk_bf16_f32 v60, v60, v60
    v_cvt_pk_bf16_f32 v61, v61, v61
    v_cvt_pk_bf16_f32 v62, v62, v62
    v_cvt_pk_bf16_f32 v63, v63, v63
    v_cvt_pk_bf16_f32 v64, v64, v64
    v_cvt_pk_bf16_f32 v65, v65, v65
    v_cvt_pk_bf16_f32 v66, v66, v66
    v_cvt_pk_bf16_f32 v67, v67, v67
    v_cvt_pk_bf16_f32 v68, v68, v68
    v_cvt_pk_bf16_f32 v69, v69, v69
    v_lshlrev_b32 v70, 16, v36
    v_and_b32 v71, 0xffff0000, v36
    v_lshlrev_b32 v72, 16, v37
    v_and_b32 v73, 0xffff0000, v37
    v_lshlrev_b32 v74, 16, v38
    v_and_b32 v75, 0xffff0000, v38
    v_lshlrev_b32 v76, 16, v39
    v_and_b32 v77, 0xffff0000, v39
    v_lshlrev_b32 v78, 16, v40
    v_and_b32 v79, 0xffff0000, v40
    v_mov_b32 v52, s46
    v_mov_b32 v53, s47
    v_sub_f32 v70, v70, v52
    v_sub_f32 v71, v71, v52
    v_sub_f32 v72, v72, v52
    v_sub_f32 v73, v73, v52
    v_sub_f32 v74, v74, v52
    v_sub_f32 v75, v75, v52
    v_sub_f32 v76, v76, v52
    v_sub_f32 v77, v77, v52
    v_sub_f32 v78, v78, v52
    v_sub_f32 v79, v79, v52
    v_cvt_pk_bf16_f32 v70, v70, v70
    v_and_b32 v70, 0xffff0000, v70
    v_cvt_pk_bf16_f32 v71, v71, v71
    v_and_b32 v71, 0xffff0000, v71
    v_cvt_pk_bf16_f32 v72, v72, v72
    v_and_b32 v72, 0xffff0000, v72
    v_cvt_pk_bf16_f32 v73, v73, v73
    v_and_b32 v73, 0xffff0000, v73
    v_cvt_pk_bf16_f32 v74, v74, v74
    v_and_b32 v74, 0xffff0000, v74
    v_cvt_pk_bf16_f32 v75, v75, v75
    v_and_b32 v75, 0xffff0000, v75
    v_cvt_pk_bf16_f32 v76, v76, v76
    v_and_b32 v76, 0xffff0000, v76
    v_cvt_pk_bf16_f32 v77, v77, v77
    v_and_b32 v77, 0xffff0000, v77
    v_cvt_pk_bf16_f32 v78, v78, v78
    v_and_b32 v78, 0xffff0000, v78
    v_cvt_pk_bf16_f32 v79, v79, v79
    v_and_b32 v79, 0xffff0000, v79
    v_mul_f32 v70, v70, v53
    v_mul_f32 v71, v71, v53
    v_mul_f32 v72, v72, v53
    v_mul_f32 v73, v73, v53
    v_mul_f32 v74, v74, v53
    v_mul_f32 v75, v75, v53
    v_mul_f32 v76, v76, v53
    v_mul_f32 v77, v77, v53
    v_mul_f32 v78, v78, v53
    v_mul_f32 v79, v79, v53
    v_cvt_pk_bf16_f32 v70, v70, v70
    v_cvt_pk_bf16_f32 v71, v71, v71
    v_cvt_pk_bf16_f32 v72, v72, v72
    v_cvt_pk_bf16_f32 v73, v73, v73
    v_cvt_pk_bf16_f32 v74, v74, v74
    v_cvt_pk_bf16_f32 v75, v75, v75
    v_cvt_pk_bf16_f32 v76, v76, v76
    v_cvt_pk_bf16_f32 v77, v77, v77
    v_cvt_pk_bf16_f32 v78, v78, v78
    v_cvt_pk_bf16_f32 v79, v79, v79
    v_and_b32 v112, v60, v48
    v_and_b32 v113, v60, v49
    v_and_b32 v114, v60, v50
    v_and_b32 v115, v60, v51
    v_and_b32 v116, v70, v48
    v_and_b32 v117, v70, v49
    v_and_b32 v118, v70, v50
    v_and_b32 v119, v70, v51
    s_waitcnt vmcnt(18)
    s_nop 0
    v_mfma_f32_16x16x32_bf16 v[96:99], v[112:115], v[128:131], 0
    v_mfma_f32_16x16x32_bf16 v[100:103], v[112:115], v[168:171], 0
    v_mfma_f32_16x16x32_bf16 v[104:107], v[116:119], v[128:131], 0
    v_mfma_f32_16x16x32_bf16 v[108:111], v[116:119], v[168:171], 0
    v_and_b32 v112, v61, v48
    v_and_b32 v113, v61, v49
    v_and_b32 v114, v61, v50
    v_and_b32 v115, v61, v51
    v_and_b32 v116, v71, v48
    v_and_b32 v117, v71, v49
    v_and_b32 v118, v71, v50
    v_and_b32 v119, v71, v51
    s_waitcnt vmcnt(16)
    s_nop 0
    v_mfma_f32_16x16x32_bf16 v[96:99], v[112:115], v[132:135], v[96:99]
    v_mfma_f32_16x16x32_bf16 v[100:103], v[112:115], v[172:175], v[100:103]
    v_mfma_f32_16x16x32_bf16 v[104:107], v[116:119], v[132:135], v[104:107]
    v_mfma_f32_16x16x32_bf16 v[108:111], v[116:119], v[172:175], v[108:111]
    v_and_b32 v112, v62, v48
    v_and_b32 v113, v62, v49
    v_and_b32 v114, v62, v50
    v_and_b32 v115, v62, v51
    v_and_b32 v116, v72, v48
    v_and_b32 v117, v72, v49
    v_and_b32 v118, v72, v50
    v_and_b32 v119, v72, v51
    s_waitcnt vmcnt(14)
    s_nop 0
    v_mfma_f32_16x16x32_bf16 v[96:99], v[112:115], v[136:139], v[96:99]
    v_mfma_f32_16x16x32_bf16 v[100:103], v[112:115], v[176:179], v[100:103]
    v_mfma_f32_16x16x32_bf16 v[104:107], v[116:119], v[136:139], v[104:107]
    v_mfma_f32_16x16x32_bf16 v[108:111], v[116:119], v[176:179], v[108:111]
    v_and_b32 v112, v63, v48
    v_and_b32 v113, v63, v49
    v_and_b32 v114, v63, v50
    v_and_b32 v115, v63, v51
    v_and_b32 v116, v73, v48
    v_and_b32 v117, v73, v49
    v_and_b32 v118, v73, v50
    v_and_b32 v119, v73, v51
    s_waitcnt vmcnt(12)
    s_nop 0
    v_mfma_f32_16x16x32_bf16 v[96:99], v[112:115], v[140:143], v[96:99]
    v_mfma_f32_16x16x32_bf16 v[100:103], v[112:115], v[180:183], v[100:103]
    v_mfma_f32_16x16x32_bf16 v[104:107], v[116:119], v[140:143], v[104:107]
    v_mfma_f32_16x16x32_bf16 v[108:111], v[116:119], v[180:183], v[108:111]
    v_and_b32 v112, v64, v48
    v_and_b32 v113, v64, v49
    v_and_b32 v114, v64, v50
    v_and_b32 v115, v64, v51
    v_and_b32 v116, v74, v48
    v_and_b32 v117, v74, v49
    v_and_b32 v118, v74, v50
    v_and_b32 v119, v74, v51
    s_waitcnt vmcnt(10)
    s_nop 0
    v_mfma_f32_16x16x32_bf16 v[96:99], v[112:115], v[144:147], v[96:99]
    v_mfma_f32_16x16x32_bf16 v[100:103], v[112:115], v[184:187], v[100:103]
    v_mfma_f32_16x16x32_bf16 v[104:107], v[116:119], v[144:147], v[104:107]
    v_mfma_f32_16x16x32_bf16 v[108:111], v[116:119], v[184:187], v[108:111]
    v_and_b32 v112, v65, v48
    v_and_b32 v113, v65, v49
    v_and_b32 v114, v65, v50
    v_and_b32 v115, v65, v51
    v_and_b32 v116, v75, v48
    v_and_b32 v117, v75, v49
    v_and_b32 v118, v75, v50
    v_and_b32 v119, v75, v51
    s_waitcnt vmcnt(8)
    s_nop 0
    v_mfma_f32_16x16x32_bf16 v[96:99], v[112:115], v[148:151], v[96:99]
    v_mfma_f32_16x16x32_bf16 v[100:103], v[112:115], v[188:191], v[100:103]
    v_mfma_f32_16x16x32_bf16 v[104:107], v[116:119], v[148:151], v[104:107]
    v_mfma_f32_16x16x32_bf16 v[108:111], v[116:119], v[188:191], v[108:111]
    v_and_b32 v112, v66, v48
    v_and_b32 v113, v66, v49
    v_and_b32 v114, v66, v50
    v_and_b32 v115, v66, v51
    v_and_b32 v116, v76, v48
    v_and_b32 v117, v76, v49
    v_and_b32 v118, v76, v50
    v_and_b32 v119, v76, v51
    s_waitcnt vmcnt(6)
    s_nop 0
    v_mfma_f32_16x16x32_bf16 v[96:99], v[112:115], v[152:155], v[96:99]
    v_mfma_f32_16x16x32_bf16 v[100:103], v[112:115], v[192:195], v[100:103]
    v_mfma_f32_16x16x32_bf16 v[104:107], v[116:119], v[152:155], v[104:107]
    v_mfma_f32_16x16x32_bf16 v[108:111], v[116:119], v[192:195], v[108:111]
    v_and_b32 v112, v67, v48
    v_and_b32 v113, v67, v49
    v_and_b32 v114, v67, v50
    v_and_b32 v115, v67, v51
    v_and_b32 v116, v77, v48
    v_and_b32 v117, v77, v49
    v_and_b32 v118, v77, v50
    v_and_b32 v119, v77, v51
    s_waitcnt vmcnt(4)
    s_nop 0
    v_mfma_f32_16x16x32_bf16 v[96:99], v[112:115], v[156:159], v[96:99]
    v_mfma_f32_16x16x32_bf16 v[100:103], v[112:115], v[196:199], v[100:103]
    v_mfma_f32_16x16x32_bf16 v[104:107], v[116:119], v[156:159], v[104:107]
    v_mfma_f32_16x16x32_bf16 v[108:111], v[116:119], v[196:199], v[108:111]
    v_and_b32 v112, v68, v48
    v_and_b32 v113, v68, v49
    v_and_b32 v114, v68, v50
    v_and_b32 v115, v68, v51
    v_and_b32 v116, v78, v48
    v_and_b32 v117, v78, v49
    v_and_b32 v118, v78, v50
    v_and_b32 v119, v78, v51
    s_waitcnt vmcnt(2)
    s_nop 0
    v_mfma_f32_16x16x32_bf16 v[96:99], v[112:115], v[160:163], v[96:99]
    v_mfma_f32_16x16x32_bf16 v[100:103], v[112:115], v[200:203], v[100:103]
    v_mfma_f32_16x16x32_bf16 v[104:107], v[116:119], v[160:163], v[104:107]
    v_mfma_f32_16x16x32_bf16 v[108:111], v[116:119], v[200:203], v[108:111]
    v_and_b32 v112, v69, v48
    v_and_b32 v113, v69, v49
    v_and_b32 v114, v69, v50
    v_and_b32 v115, v69, v51
    v_and_b32 v116, v79, v48
    v_and_b32 v117, v79, v49
    v_and_b32 v118, v79, v50
    v_and_b32 v119, v79, v51
    s_waitcnt vmcnt(0)
    s_nop 0
    v_mfma_f32_16x16x32_bf16 v[96:99], v[112:115], v[164:167], v[96:99]
    v_mfma_f32_16x16x32_bf16 v[100:103], v[112:115], v[204:207], v[100:103]
    v_mfma_f32_16x16x32_bf16 v[104:107], v[116:119], v[164:167], v[104:107]
    v_mfma_f32_16x16x32_bf16 v[108:111], v[116:119], v[204:207], v[108:111]
    v_add_u32 v6, 40, v0
    v_and_b32 v6, 63, v6
    v_lshlrev_b32 v6, 2, v6
    s_nop 7
    ds_bpermute_b32 v112, v6, v96
    ds_bpermute_b32 v113, v6, v97
    ds_bpermute_b32 v114, v6, v98
    ds_bpermute_b32 v115, v6, v99
    ds_bpermute_b32 v116, v6, v100
    ds_bpermute_b32 v117, v6, v101
    ds_bpermute_b32 v118, v6, v102
    ds_bpermute_b32 v119, v6, v103
    ds_bpermute_b32 v120, v6, v104
    ds_bpermute_b32 v121, v6, v105
    ds_bpermute_b32 v122, v6, v106
    ds_bpermute_b32 v123, v6, v107
    ds_bpermute_b32 v124, v6, v108
    ds_bpermute_b32 v125, v6, v109
    ds_bpermute_b32 v126, v6, v110
    ds_bpermute_b32 v127, v6, v111
    s_lshl_b32 s70, s61, 14
    s_lshl_b32 s71, s62, 11
    s_add_u32 s70, s70, s71
    s_add_u32 s70, s70, 0x160000
    v_lshlrev_b32 v6, 5, v3
    v_lshlrev_b32 v7, 4, v2
    v_add3_u32 v6, v6, v7, s70
    s_waitcnt lgkmcnt(0)
    v_add_f32 v128, v96, v112
    v_add_f32 v129, v97, v113
    v_mov_b32 v130, s100
    v_mov_b32 v131, s101
    v_add_f32 v132, v98, v114
    v_add_f32 v133, v99, v115
    v_mov_b32 v134, s100
    v_mov_b32 v135, s101
    v_add_f32 v136, v100, v116
    v_add_f32 v137, v101, v117
    v_mov_b32 v138, s100
    v_mov_b32 v139, s101
    v_add_f32 v140, v102, v118
    v_add_f32 v141, v103, v119
    v_mov_b32 v142, s100
    v_mov_b32 v143, s101
    v_add_f32 v144, v104, v120
    v_add_f32 v145, v105, v121
    v_mov_b32 v146, s100
    v_mov_b32 v147, s101
    v_add_f32 v148, v106, v122
    v_add_f32 v149, v107, v123
    v_mov_b32 v150, s100
    v_mov_b32 v151, s101
    v_add_f32 v152, v108, v124
    v_add_f32 v153, v109, v125
    v_mov_b32 v154, s100
    v_mov_b32 v155, s101
    v_add_f32 v156, v110, v126
    v_add_f32 v157, v111, v127
    v_mov_b32 v158, s100
    v_mov_b32 v159, s101
    s_mov_b32 exec_lo, 0xff00ff
    s_mov_b32 exec_hi, 0x0
    s_cmp_eq_u32 s97, 0
    s_cbranch_scc1 L_far_pa
    buffer_store_dwordx4 v[128:131], v6, s[56:59], 0 offen offset:0
    buffer_store_dwordx4 v[132:135], v6, s[56:59], 0 offen offset:256
    buffer_store_dwordx4 v[136:139], v6, s[56:59], 0 offen offset:512
    buffer_store_dwordx4 v[140:143], v6, s[56:59], 0 offen offset:768
    buffer_store_dwordx4 v[144:147], v6, s[56:59], 0 offen offset:1024
    buffer_store_dwordx4 v[148:151], v6, s[56:59], 0 offen offset:1280
    buffer_store_dwordx4 v[152:155], v6, s[56:59], 0 offen offset:1536
    buffer_store_dwordx4 v[156:159], v6, s[56:59], 0 offen offset:1792
L_near_pa:
    s_mov_b64 exec, -1
L_noA:
    s_mov_b32 s44, s20
    s_and_b32 s45, s21, 0xffff
    s_mov_b32 s46, 0x21c000
    s_mov_b32 s47, 0x20000
    v_mul_u32_u24 v6, 205, v0
    v_lshrrev_b32 v6, 11, v6
    v_mul_u32_u24 v7, 10, v6
    v_sub_u32 v7, v0, v7
    v_mul_u32_u24 v6, 1280, v6
    v_lshl_add_u32 v6, v7, 4, v6
    s_mul_i32 s64, s62, 160
    v_add_u32 v6, s64, v6
    s_mul_i32 s64, s55, 1280
    s_mov_b32 s65, s64
    s_mov_b32 m0, 43008
    s_nop 0
    buffer_load_dwordx4 v6, s[44:47], s65 offen nt lds
    s_add_u32 s65, s65, 7680
    s_mov_b32 m0, 43968
    s_nop 0
    buffer_load_dwordx4 v6, s[44:47], s65 offen nt lds
    s_add_u32 s65, s65, 7680
    s_mov_b32 m0, 44928
    s_nop 0
    buffer_load_dwordx4 v6, s[44:47], s65 offen nt lds
    s_add_u32 s65, s65, 7680
    s_mov_b32 m0, 45888
    s_nop 0
    buffer_load_dwordx4 v6, s[44:47], s65 offen nt lds
    s_add_u32 s65, s65, 7680
    s_mov_b32 m0, 46848
    s_nop 0
    buffer_load_dwordx4 v6, s[44:47], s65 offen nt lds
    s_add_u32 s65, s65, 7680
    s_mov_b32 m0, 47808
    s_nop 0
    buffer_load_dwordx4 v6, s[44:47], s65 offen nt lds
    s_add_u32 s65, s65, 7680
    s_mov_b32 m0, 48768
    s_nop 0
    buffer_load_dwordx4 v6, s[44:47], s65 offen nt lds
    s_add_u32 s65, s65, 7680
    s_mov_b32 m0, 49728
    s_nop 0
    buffer_load_dwordx4 v6, s[44:47], s65 offen nt lds
    s_add_u32 s65, s65, 7680
    s_mov_b32 m0, 50688
    s_nop 0
    buffer_load_dwordx4 v6, s[44:47], s65 offen nt lds
    s_add_u32 s65, s65, 7680
    s_mov_b32 m0, 51648
    s_nop 0
    buffer_load_dwordx4 v6, s[44:47], s65 offen nt lds
    s_add_u32 s65, s65, 7680
    s_mov_b32 m0, 52608
    s_nop 0
    buffer_load_dwordx4 v6, s[44:47], s65 offen nt lds
    s_add_u32 s65, s65, 7680
    v_mov_b32 v119, v6
    v_lshrrev_b32 v7, 2, v3
    v_lshl_add_u32 v7, v2, 3, v7
    v_mul_u32_u24 v7, 160, v7
    v_and_b32 v8, 3, v3
    v_lshl_add_u32 v7, v8, 3, v7
    s_waitcnt vmcnt(0)
    ds_read_b64_tr_b16 v[208:209], v7 offset:43008
    ds_read_b64_tr_b16 v[210:211], v7 offset:43648
    ds_read_b64_tr_b16 v[212:213], v7 offset:48128
    ds_read_b64_tr_b16 v[214:215], v7 offset:48768
    s_waitcnt lgkmcnt(0)
    ds_read_b64_tr_b16 v[216:217], v7 offset:43040
    ds_read_b64_tr_b16 v[218:219], v7 offset:43680
    ds_read_b64_tr_b16 v[220:221], v7 offset:48160
    ds_read_b64_tr_b16 v[222:223], v7 offset:48800
    s_waitcnt lgkmcnt(0)
    ds_read_b64_tr_b16 v[224:225], v7 offset:43072
    ds_read_b64_tr_b16 v[226:227], v7 offset:43712
    ds_read_b64_tr_b16 v[228:229], v7 offset:48192
    ds_read_b64_tr_b16 v[230:231], v7 offset:48832
    s_waitcnt lgkmcnt(0)
    ds_read_b64_tr_b16 v[232:233], v7 offset:43104
    ds_read_b64_tr_b16 v[234:235], v7 offset:43744
    ds_read_b64_tr_b16 v[236:237], v7 offset:48224
    ds_read_b64_tr_b16 v[238:239], v7 offset:48864
    s_waitcnt lgkmcnt(0)
    ds_read_b64_tr_b16 v[240:241], v7 offset:43136
    ds_read_b64_tr_b16 v[242:243], v7 offset:43776
    ds_read_b64_tr_b16 v[244:245], v7 offset:48256
    ds_read_b64_tr_b16 v[246:247], v7 offset:48896
    s_waitcnt lgkmcnt(0)
    v_mov_b32 v122, v7
    v_lshlrev_b32 v6, 4, v3
    v_lshlrev_b32 v7, 9, v2
    s_lshl_b32 s64, s61, 14
    s_add_u32 s64, s64, 0x160000
    v_add3_u32 v6, v6, v7, s64
L_pollA:
    s_mov_b32 s64, 0
    buffer_load_dwordx4 v[48:51], v6, s[56:59], s64 offen offset:0 sc1
    buffer_load_dwordx4 v[52:55], v6, s[56:59], s64 offen offset:256 sc1
    buffer_load_dwordx4 v[56:59], v6, s[56:59], s64 offen offset:2048 sc1
    buffer_load_dwordx4 v[60:63], v6, s[56:59], s64 offen offset:2304 sc1
    s_mov_b32 s64, 4096
    buffer_load_dwordx4 v[64:67], v6, s[56:59], s64 offen offset:0 sc1
    buffer_load_dwordx4 v[68:71], v6, s[56:59], s64 offen offset:256 sc1
    buffer_load_dwordx4 v[72:75], v6, s[56:59], s64 offen offset:2048 sc1
    buffer_load_dwordx4 v[76:79], v6, s[56:59], s64 offen offset:2304 sc1
    s_mov_b32 s64, 8192
    buffer_load_dwordx4 v[80:83], v6, s[56:59], s64 offen offset:0 sc1
    buffer_load_dwordx4 v[84:87], v6, s[56:59], s64 offen offset:256 sc1
    buffer_load_dwordx4 v[88:91], v6, s[56:59], s64 offen offset:2048 sc1
    buffer_load_dwordx4 v[92:95], v6, s[56:59], s64 offen offset:2304 sc1
    s_mov_b32 s64, 12288
    buffer_load_dwordx4 v[96:99], v6, s[56:59], s64 offen offset:0 sc1
    buffer_load_dwordx4 v[100:103], v6, s[56:59], s64 offen offset:256 sc1
    buffer_load_dwordx4 v[104:107], v6, s[56:59], s64 offen offset:2048 sc1
    buffer_load_dwordx4 v[108:111], v6, s[56:59], s64 offen offset:2304 sc1
    s_waitcnt vmcnt(0)
    v_cmp_ne_u64 vcc, s[100:101], v[50:51]
    v_cmp_ne_u64 s[70:71], s[100:101], v[54:55]
    s_or_b64 vcc, vcc, s[70:71]
    v_cmp_ne_u64 s[70:71], s[100:101], v[58:59]
    s_or_b64 vcc, vcc, s[70:71]
    v_cmp_ne_u64 s[70:71], s[100:101], v[62:63]
    s_or_b64 vcc, vcc, s[70:71]
    v_cmp_ne_u64 s[70:71], s[100:101], v[66:67]
    s_or_b64 vcc, vcc, s[70:71]
    v_cmp_ne_u64 s[70:71], s[100:101], v[70:71]
    s_or_b64 vcc, vcc, s[70:71]
    v_cmp_ne_u64 s[70:71], s[100:101], v[74:75]
    s_or_b64 vcc, vcc, s[70:71]
    v_cmp_ne_u64 s[70:71], s[100:101], v[78:79]
    s_or_b64 vcc, vcc, s[70:71]
    v_cmp_ne_u64 s[70:71], s[100:101], v[82:83]
    s_or_b64 vcc, vcc, s[70:71]
    v_cmp_ne_u64 s[70:71], s[100:101], v[86:87]
    s_or_b64 vcc, vcc, s[70:71]
    v_cmp_ne_u64 s[70:71], s[100:101], v[90:91]
    s_or_b64 vcc, vcc, s[70:71]
    v_cmp_ne_u64 s[70:71], s[100:101], v[94:95]
    s_or_b64 vcc, vcc, s[70:71]
    v_cmp_ne_u64 s[70:71], s[100:101], v[98:99]
    s_or_b64 vcc, vcc, s[70:71]
    v_cmp_ne_u64 s[70:71], s[100:101], v[102:103]
    s_or_b64 vcc, vcc, s[70:71]
    v_cmp_ne_u64 s[70:71], s[100:101], v[106:107]
    s_or_b64 vcc, vcc, s[70:71]
    v_cmp_ne_u64 s[70:71], s[100:101], v[110:111]
    s_or_b64 vcc, vcc, s[70:71]
    s_cbranch_vccz L_pollA_ok
    s_sleep 32
    s_sub_u32 s98, s98, 1
    s_cbranch_scc0 L_pollA
L_pollA_ok:
    v_add_f32 v48, v48, v80
    v_add_f32 v49, v49, v81
    v_add_f32 v52, v52, v84
    v_add_f32 v53, v53, v85
    v_add_f32 v56, v56, v88
    v_add_f32 v57, v57, v89
    v_add_f32 v60, v60, v92
    v_add_f32 v61, v61, v93
    v_add_f32 v64, v64, v96
    v_add_f32 v65, v65, v97
    v_add_f32 v68, v68, v100
    v_add_f32 v69, v69, v101
    v_add_f32 v72, v72, v104
    v_add_f32 v73, v73, v105
    v_add_f32 v76, v76, v108
    v_add_f32 v77, v77, v109
    v_add_f32 v48, v48, v64
    v_add_f32 v49, v49, v65
    v_add_f32 v52, v52, v68
    v_add_f32 v53, v53, v69
    v_add_f32 v56, v56, v72
    v_add_f32 v57, v57, v73
    v_add_f32 v60, v60, v76
    v_add_f32 v61, v61, v77
    v_add_f32 v48, v48, v56
    v_add_f32 v49, v49, v57
    v_add_f32 v52, v52, v60
    v_add_f32 v53, v53, v61
    v_cvt_pk_bf16_f32 v12, v48, v48
    v_and_b32 v12, 0xffff0000, v12
    v_cvt_pk_bf16_f32 v13, v49, v49
    v_and_b32 v13, 0xffff0000, v13
    v_cvt_pk_bf16_f32 v14, v52, v52
    v_and_b32 v14, 0xffff0000, v14
    v_cvt_pk_bf16_f32 v15, v53, v53
    v_and_b32 v15, 0xffff0000, v15
    v_and_b32 v9, 1, v0
    v_lshlrev_b32 v9, 8, v9
    v_lshl_add_u32 v9, v2, 4, v9
    v_lshrrev_b32 v8, 5, v0
    v_lshlrev_b32 v8, 8, v8
    v_lshl_add_u32 v8, v3, 3, v8
    s_lshl_b32 s64, s68, 2
    v_cmp_gt_u32 vcc, s64, v3
    v_mov_b32 v16, v12
    v_mov_b32 v17, v13
    v_mov_b32 v18, v14
    v_mov_b32 v19, v15
    s_nop 0
    v_permlane16_swap_b32 v12, v16
    v_permlane16_swap_b32 v13, v17
    v_permlane16_swap_b32 v14, v18
    v_permlane16_swap_b32 v15, v19
    s_nop 0
    v_mul_f32 v12, v12, v16
    v_mul_f32 v13, v13, v17
    v_mul_f32 v14, v14, v18
    v_mul_f32 v15, v15, v19
    v_cvt_pk_bf16_f32 v12, v12, v13
    v_cvt_pk_bf16_f32 v13, v14, v15
    v_cndmask_b32 v12, 0, v12, vcc
    v_cndmask_b32 v13, 0, v13, vcc
    ds_write_b64 v8, v[12:13] offset:4352
    v_mov_b32 v48, 0
    v_mov_b32 v49, 0
    v_mov_b32 v50, 0
    v_mov_b32 v51, 0
    v_mov_b32 v52, 0
    v_mov_b32 v53, 0
    v_mov_b32 v54, 0
    v_mov_b32 v55, 0
    v_mov_b32 v56, 0
    v_mov_b32 v57, 0
    v_mov_b32 v58, 0
    v_mov_b32 v59, 0
    v_mov_b32 v60, 0
    v_mov_b32 v61, 0
    v_mov_b32 v62, 0
    v_mov_b32 v63, 0
    v_mov_b32 v64, 0
    v_mov_b32 v65, 0
    v_mov_b32 v66, 0
    v_mov_b32 v67, 0
    v_mov_b32 v68, 0
    v_mov_b32 v69, 0
    v_mov_b32 v70, 0
    v_mov_b32 v71, 0
    v_mov_b32 v72, 0
    v_mov_b32 v73, 0
    v_mov_b32 v74, 0
    v_mov_b32 v75, 0
    v_mov_b32 v76, 0
    v_mov_b32 v77, 0
    v_mov_b32 v78, 0
    v_mov_b32 v79, 0
    v_mov_b32 v80, 0
    v_mov_b32 v81, 0
    v_mov_b32 v82, 0
    v_mov_b32 v83, 0
    v_mov_b32 v84, 0
    v_mov_b32 v85, 0
    v_mov_b32 v86, 0
    v_mov_b32 v87, 0
    s_waitcnt lgkmcnt(0)
    s_mov_b32 exec_lo, 0x30003
    s_mov_b32 exec_hi, 0x30003
    ds_read_b128 v[48:51], v9 offset:4352
    ds_read_b128 v[52:55], v9 offset:4416
    s_mov_b32 exec_lo, 0xc000c
    s_mov_b32 exec_hi, 0xc000c
    ds_read_b128 v[56:59], v9 offset:4352
    ds_read_b128 v[60:63], v9 offset:4416
    s_mov_b32 exec_lo, 0x300030
    s_mov_b32 exec_hi, 0x300030
    ds_read_b128 v[64:67], v9 offset:4352
    ds_read_b128 v[68:71], v9 offset:4416
    s_mov_b32 exec_lo, 0xc000c0
    s_mov_b32 exec_hi, 0xc000c0
    ds_read_b128 v[72:75], v9 offset:4352
    ds_read_b128 v[76:79], v9 offset:4416
    s_mov_b32 exec_lo, 0x3000300
    s_mov_b32 exec_hi, 0x3000300
    ds_read_b128 v[80:83], v9 offset:4352
    ds_read_b128 v[84:87], v9 offset:4416
    s_mov_b64 exec, -1
    s_waitcnt lgkmcnt(0)
    v_mfma_f32_16x16x32_bf16 v[28:31], v[208:211], v[48:51], 0
    v_mfma_f32_16x16x32_bf16 v[28:31], v[212:215], v[52:55], v[28:31]
    v_mfma_f32_16x16x32_bf16 v[28:31], v[216:219], v[56:59], v[28:31]
    v_mfma_f32_16x16x32_bf16 v[28:31], v[220:223], v[60:63], v[28:31]
    v_mfma_f32_16x16x32_bf16 v[28:31], v[224:227], v[64:67], v[28:31]
    v_mfma_f32_16x16x32_bf16 v[28:31], v[228:231], v[68:71], v[28:31]
    v_mfma_f32_16x16x32_bf16 v[28:31], v[232:235], v[72:75], v[28:31]
    v_mfma_f32_16x16x32_bf16 v[28:31], v[236:239], v[76:79], v[28:31]
    v_mfma_f32_16x16x32_bf16 v[28:31], v[240:243], v[80:83], v[28:31]
    v_mfma_f32_16x16x32_bf16 v[28:31], v[244:247], v[84:87], v[28:31]
    s_lshl_b32 s64, s62, 5
    s_add_u32 s64, s64, s61
    s_mul_i32 s65, s64, 1280
    v_lshl_add_u32 v114, v0, 4, s65
    v_lshlrev_b32 v113, 6, v3
    v_lshl_add_u32 v113, v2, 4, v113
    v_lshlrev_b32 v118, 3, v0
    v_mov_b32 v106, s100
    v_mov_b32 v107, s101
    v_mov_b32 v110, s100
    v_mov_b32 v111, s101
    ds_write_b128 v113, v[28:31] offset:512
    s_waitcnt lgkmcnt(0)
    ds_read_b64 v[104:105], v118 offset:512
    ds_read_b64 v[108:109], v118 offset:1024
    s_waitcnt lgkmcnt(1)
    buffer_store_dwordx4 v[104:107], v114, s[56:59], 0 offen sc1
    s_mov_b64 exec, 0xffff
    s_waitcnt lgkmcnt(0)
    buffer_store_dwordx4 v[108:111], v114, s[56:59], 0 offen offset:1024 sc1
    s_mov_b64 exec, -1
    v_mov_b32 v208, 0
    v_mov_b32 v209, 0
    v_mov_b32 v210, 0
    v_mov_b32 v211, 0
    v_mov_b32 v212, 0
    v_mov_b32 v213, 0
    v_mov_b32 v214, 0
    v_mov_b32 v215, 0
    v_mov_b32 v216, 0
    v_mov_b32 v217, 0
    v_mov_b32 v218, 0
    v_mov_b32 v219, 0
    v_mov_b32 v220, 0
    v_mov_b32 v221, 0
    v_mov_b32 v222, 0
    v_mov_b32 v223, 0
    v_mov_b32 v224, 0
    v_mov_b32 v225, 0
    v_mov_b32 v226, 0
    v_mov_b32 v227, 0
    v_mov_b32 v228, 0
    v_mov_b32 v229, 0
    v_mov_b32 v230, 0
    v_mov_b32 v231, 0
    v_mov_b32 v232, 0
    v_mov_b32 v233, 0
    v_mov_b32 v234, 0
    v_mov_b32 v235, 0
    v_mov_b32 v236, 0
    v_mov_b32 v237, 0
    v_mov_b32 v238, 0
    v_mov_b32 v239, 0
    v_mov_b32 v240, 0
    v_mov_b32 v241, 0
    v_mov_b32 v242, 0
    v_mov_b32 v243, 0
    v_mov_b32 v244, 0
    v_mov_b32 v245, 0
    v_mov_b32 v246, 0
    v_mov_b32 v247, 0
    v_mov_b32 v248, 0
    v_mov_b32 v249, 0
    v_mov_b32 v250, 0
    v_mov_b32 v251, 0
    v_mov_b32 v252, 0
    v_mov_b32 v253, 0
    v_mov_b32 v254, 0
    v_mov_b32 v255, 0
    v_mov_b32 v64, 0
    v_mov_b32 v65, 0
    v_mov_b32 v66, 0
    v_mov_b32 v67, 0
    v_mov_b32 v68, 0
    v_mov_b32 v69, 0
    v_mov_b32 v70, 0
    v_mov_b32 v71, 0
    v_mov_b32 v72, 0
    v_mov_b32 v73, 0
    v_mov_b32 v74, 0
    v_mov_b32 v75, 0
    v_mov_b32 v76, 0
    v_mov_b32 v77, 0
    v_mov_b32 v78, 0
    v_mov_b32 v79, 0
    v_mov_b32 v80, 0
    v_mov_b32 v81, 0
    v_mov_b32 v82, 0
    v_mov_b32 v83, 0
    v_mov_b32 v84, 0
    v_mov_b32 v85, 0
    v_mov_b32 v86, 0
    v_mov_b32 v87, 0
    v_mov_b32 v88, 0
    v_mov_b32 v89, 0
    v_mov_b32 v90, 0
    v_mov_b32 v91, 0
    v_mov_b32 v92, 0
    v_mov_b32 v93, 0
    v_mov_b32 v94, 0
    v_mov_b32 v95, 0
    s_lshl_b32 s64, s62, 2
    s_sub_u32 s64, s61, s64
    s_and_b32 s68, s64, 31
    s_cmp_lt_u32 s68, 10
    s_cselect_b32 s69, 1, 0
    s_cbranch_scc0 L_noG
    v_lshrrev_b32 v10, 3, v0
    v_and_b32 v11, 7, v0
    v_mul_u32_u24 v115, 1280, v10
    v_lshl_add_u32 v115, v11, 4, v115
    s_mul_i32 s65, s62, 40960
    s_lshl_b32 s70, s68, 7
    s_add_u32 s65, s65, s70
    v_add_u32 v115, s65, v115
    s_and_b32 s64, s68, 1
    s_mul_i32 s64, s64, 1280
    s_mul_i32 s65, s62, 160
    s_add_u32 s64, s64, s65
    s_lshr_b32 s65, s68, 1
    s_lshl_b32 s65, s65, 5
    s_add_u32 s64, s64, s65
    v_lshl_add_u32 v42, v11, 2, s64
    buffer_load_dword v112, v42, s[28:31], 0 offen
    s_mov_b32 s64, 458752
    buffer_load_dwordx4 v[12:15], v115, s[56:59], s64 offen sc1
    s_mov_b32 s64, 468992
    buffer_load_dwordx4 v[16:19], v115, s[56:59], s64 offen sc1
    s_mov_b32 s64, 479232
    buffer_load_dwordx4 v[20:23], v115, s[56:59], s64 offen sc1
    s_mov_b32 s64, 489472
    buffer_load_dwordx4 v[24:27], v115, s[56:59], s64 offen sc1
    s_waitcnt vmcnt(0)
    v_lshlrev_b32 v120, 16, v112
    v_and_b32 v121, 0xffff0000, v112
L_noG:
    s_mov_b32 s53, 0x3fb8aa3b
    v_mov_b32 v1, 0
    s_lshl_b32 s64, s61, 7
    s_add_u32 s64, s64, 0x60000
    s_lshl_b32 s65, s62, 4
    s_add_u32 s54, s65, s64
    s_lshl_b32 s65, s63, 6
    s_add_u32 s64, s64, s65
    v_and_b32 v7, 3, v0
    v_lshl_add_u32 v7, v7, 4, s64
L_waitK:
    ds_read_b32 v12, v1 offset:4164
    s_waitcnt lgkmcnt(0)
    v_readfirstlane_b32 s70, v12
    s_cmp_ge_u32 s70, 4
    s_cbranch_scc1 L_waitK_ok
    s_sleep 1
    s_sub_u32 s99, s99, 1
    s_cbranch_scc0 L_waitK
L_waitK_ok:
    ds_read_b128 v[12:15], v1 offset:4096
    ds_read_b128 v[16:19], v1 offset:4112
    s_waitcnt lgkmcnt(0)
    v_max3_f32 v20, v12, v14, v16
    v_max_f32 v20, v20, v18
    v_sub_f32 v24, v12, v20
    v_sub_f32 v25, v14, v20
    v_sub_f32 v26, v16, v20
    v_sub_f32 v27, v18, v20
    v_mul_f32 v24, s53, v24
    v_mul_f32 v25, s53, v25
    v_mul_f32 v26, s53, v26
    v_mul_f32 v27, s53, v27
    v_exp_f32 v24, v24
    v_exp_f32 v25, v25
    v_exp_f32 v26, v26
    v_exp_f32 v27, v27
    s_nop 0
    v_mul_f32 v21, v24, v13
    v_fmac_f32 v21, v25, v15
    v_fmac_f32 v21, v26, v17
    v_fmac_f32 v21, v27, v19
    v_mov_b32 v28, v20
    v_mov_b32 v29, v21
    v_mov_b32 v30, s100
    v_mov_b32 v31, s101
    s_mov_b64 exec, 1
    s_cmp_eq_u32 s97, 0
    s_cbranch_scc1 L_far_ml
    buffer_store_dwordx4 v[28:31], off, s[56:59], s54
L_near_ml:
    s_mov_b64 exec, -1
L_pollM:
    buffer_load_dwordx4 v[32:35], v7, s[56:59], 0 offen sc1
    s_waitcnt vmcnt(0)
    v_cmp_ne_u64 vcc, s[100:101], v[34:35]
    s_cbranch_vccz L_pollM_ok
    s_sleep 8
    s_sub_u32 s98, s98, 1
    s_cbranch_scc0 L_pollM
L_pollM_ok:
    v_max_f32_dpp v36, v32, v32 quad_perm:[1,0,3,2] row_mask:0xf bank_mask:0xf
    s_nop 1
    v_max_f32_dpp v36, v36, v36 quad_perm:[2,3,0,1] row_mask:0xf bank_mask:0xf
    v_sub_f32 v37, v32, v36
    v_mul_f32 v37, s53, v37
    v_exp_f32 v37, v37
    s_nop 0
    v_mul_f32 v37, v37, v33
    s_nop 1
    v_add_f32_dpp v37, v37, v37 quad_perm:[1,0,3,2] row_mask:0xf bank_mask:0xf
    s_nop 1
    v_add_f32_dpp v37, v37, v37 quad_perm:[2,3,0,1] row_mask:0xf bank_mask:0xf
    v_sub_f32 v36, v20, v36
    v_mul_f32 v36, s53, v36
    v_exp_f32 v36, v36
    v_rcp_f32 v37, v37
    s_nop 0
    v_mul_f32 v36, v36, v37
    v_mul_f32 v37, v36, v24
    v_mul_f32 v38, v36, v25
    v_mul_f32 v39, v36, v26
    v_mul_f32 v40, v36, v27
    v_lshrrev_b32 v10, 5, v0
    v_and_b32 v11, 31, v0
    s_lshl_b32 s64, s61, 12
    s_add_u32 s64, s64, 0xc0000
    v_lshl_add_u32 v6, v0, 4, s64
    v_lshlrev_b32 v8, 4, v11
    v_lshlrev_b32 v7, 3, v11
    v_lshl_add_u32 v7, v10, 8, v7
    s_mov_b32 s52, 0x70000
L_waitW:
    ds_read_b32 v12, v1 offset:4172
    s_waitcnt lgkmcnt(0)
    v_readfirstlane_b32 s70, v12
    s_cmp_ge_u32 s70, 4
    s_cbranch_scc1 L_waitW_ok
    s_sleep 1
    s_sub_u32 s99, s99, 1
    s_cbranch_scc0 L_waitW
L_waitW_ok:
    s_setprio 3
    s_mul_i32 s65, s61, 163840
    s_mov_b32 m0, 21504
    s_nop 0
    buffer_load_dwordx4 v119, s[40:43], s65 offen nt lds
    s_add_u32 s65, s65, 7680
    s_mov_b32 m0, 22464
    s_nop 0
    buffer_load_dwordx4 v119, s[40:43], s65 offen nt lds
    s_add_u32 s65, s65, 7680
    s_mov_b32 m0, 23424
    s_nop 0
    buffer_load_dwordx4 v119, s[40:43], s65 offen nt lds
    s_add_u32 s65, s65, 7680
    s_mov_b32 m0, 24384
    s_nop 0
    buffer_load_dwordx4 v119, s[40:43], s65 offen nt lds
    s_add_u32 s65, s65, 7680
    s_mov_b32 m0, 25344
    s_nop 0
    buffer_load_dwordx4 v119, s[40:43], s65 offen nt lds
    s_add_u32 s65, s65, 7680
    s_mov_b32 m0, 26304
    s_nop 0
    buffer_load_dwordx4 v119, s[40:43], s65 offen nt lds
    s_add_u32 s65, s65, 7680
    s_mov_b32 m0, 27264
    s_nop 0
    buffer_load_dwordx4 v119, s[40:43], s65 offen nt lds
    s_add_u32 s65, s65, 7680
    s_mov_b32 m0, 28224
    s_nop 0
    buffer_load_dwordx4 v119, s[40:43], s65 offen nt lds
    s_add_u32 s65, s65, 7680
    s_mov_b32 m0, 29184
    s_nop 0
    buffer_load_dwordx4 v119, s[40:43], s65 offen nt lds
    s_add_u32 s65, s65, 7680
    s_mov_b32 m0, 30144
    s_nop 0
    buffer_load_dwordx4 v119, s[40:43], s65 offen nt lds
    s_add_u32 s65, s65, 7680
    s_mov_b32 m0, 31104
    s_nop 0
    buffer_load_dwordx4 v119, s[40:43], s65 offen nt lds
    s_add_u32 s65, s65, 7680
    s_mov_b32 m0, 32064
    s_nop 0
    buffer_load_dwordx4 v119, s[40:43], s65 offen nt lds
    s_add_u32 s65, s65, 7680
    s_mov_b32 m0, 33024
    s_nop 0
    buffer_load_dwordx4 v119, s[40:43], s65 offen nt lds
    s_add_u32 s65, s65, 7680
    s_mov_b32 m0, 33984
    s_nop 0
    buffer_load_dwordx4 v119, s[40:43], s65 offen nt lds
    s_add_u32 s65, s65, 7680
    s_mov_b32 m0, 34944
    s_nop 0
    buffer_load_dwordx4 v119, s[40:43], s65 offen nt lds
    s_add_u32 s65, s65, 7680
    s_mov_b32 m0, 35904
    s_nop 0
    buffer_load_dwordx4 v119, s[40:43], s65 offen nt lds
    s_add_u32 s65, s65, 7680
    s_mov_b32 m0, 36864
    s_nop 0
    buffer_load_dwordx4 v119, s[40:43], s65 offen nt lds
    s_add_u32 s65, s65, 7680
    s_mov_b32 m0, 37824
    s_nop 0
    buffer_load_dwordx4 v119, s[40:43], s65 offen nt lds
    s_add_u32 s65, s65, 7680
    s_mov_b32 m0, 38784
    s_nop 0
    buffer_load_dwordx4 v119, s[40:43], s65 offen nt lds
    s_add_u32 s65, s65, 7680
    s_mov_b32 m0, 39744
    s_nop 0
    buffer_load_dwordx4 v119, s[40:43], s65 offen nt lds
    s_add_u32 s65, s65, 7680
    s_mov_b32 m0, 40704
    s_nop 0
    buffer_load_dwordx4 v119, s[40:43], s65 offen nt lds
    s_add_u32 s65, s65, 7680
    s_mov_b32 m0, 41664
    s_nop 0
    buffer_load_dwordx4 v119, s[40:43], s65 offen nt lds
    s_add_u32 s65, s65, 7680
L_waitS:
    ds_read_b32 v12, v1 offset:4160
    s_waitcnt lgkmcnt(0)
    v_readfirstlane_b32 s70, v12
    s_cmp_ge_u32 s70, 4
    s_cbranch_scc1 L_waitS_ok
    s_sleep 1
    s_sub_u32 s99, s99, 1
    s_cbranch_scc0 L_waitS
L_waitS_ok:
    s_setprio 3
    ds_read_b128 v[20:23], v8 offset:2048
    ds_read_b128 v[24:27], v8 offset:2560
    ds_read_b128 v[28:31], v8 offset:3072
    ds_read_b128 v[32:35], v8 offset:3584
    s_mov_b32 exec_hi, 0
    s_waitcnt lgkmcnt(3)
    v_mul_f32 v20, v37, v20
    v_mul_f32 v21, v37, v21
    v_mul_f32 v22, v37, v22
    v_mul_f32 v23, v37, v23
    s_waitcnt lgkmcnt(2)
    v_fmac_f32 v20, v38, v24
    v_fmac_f32 v21, v38, v25
    v_fmac_f32 v22, v38, v26
    v_fmac_f32 v23, v38, v27
    s_waitcnt lgkmcnt(1)
    v_fmac_f32 v20, v39, v28
    v_fmac_f32 v21, v39, v29
    v_fmac_f32 v22, v39, v30
    v_fmac_f32 v23, v39, v31
    s_waitcnt lgkmcnt(0)
    v_fmac_f32 v20, v40, v32
    v_fmac_f32 v21, v40, v33
    v_fmac_f32 v22, v40, v34
    v_fmac_f32 v23, v40, v35
    v_min_u32 v20, -2, v20
    v_min_u32 v21, -2, v21
    v_min_u32 v22, -2, v22
    v_min_u32 v23, -2, v23
    s_cmp_eq_u32 s97, 0
    s_cbranch_scc1 L_far_o
    buffer_store_dwordx4 v[20:23], v4, s[56:59], 0 offen
L_near_o:
    s_mov_b32 exec_hi, -1
    s_mov_b32 s55, 15
    buffer_load_dwordx4 v[48:51], v6, s[56:59], 0 offen offset:0 sc1
    buffer_load_dwordx4 v[52:55], v6, s[56:59], 0 offen offset:1024 sc1
    buffer_load_dwordx4 v[56:59], v6, s[56:59], 0 offen offset:2048 sc1
    buffer_load_dwordx4 v[60:63], v6, s[56:59], 0 offen offset:3072 sc1
    s_waitcnt vmcnt(5)
    ds_read_b64_tr_b16 v[128:129], v122 offset:21504
    ds_read_b64_tr_b16 v[130:131], v122 offset:22144
    ds_read_b64_tr_b16 v[132:133], v122 offset:26624
    ds_read_b64_tr_b16 v[134:135], v122 offset:27264
    ds_read_b64_tr_b16 v[136:137], v122 offset:31744
    ds_read_b64_tr_b16 v[138:139], v122 offset:32384
    ds_read_b64_tr_b16 v[140:141], v122 offset:36864
    ds_read_b64_tr_b16 v[142:143], v122 offset:37504
    s_waitcnt lgkmcnt(0)
    ds_read_b64_tr_b16 v[144:145], v122 offset:21536
    ds_read_b64_tr_b16 v[146:147], v122 offset:22176
    ds_read_b64_tr_b16 v[148:149], v122 offset:26656
    ds_read_b64_tr_b16 v[150:151], v122 offset:27296
    ds_read_b64_tr_b16 v[152:153], v122 offset:31776
    ds_read_b64_tr_b16 v[154:155], v122 offset:32416
    ds_read_b64_tr_b16 v[156:157], v122 offset:36896
    ds_read_b64_tr_b16 v[158:159], v122 offset:37536
    s_waitcnt lgkmcnt(0)
    ds_read_b64_tr_b16 v[160:161], v122 offset:21568
    ds_read_b64_tr_b16 v[162:163], v122 offset:22208
    ds_read_b64_tr_b16 v[164:165], v122 offset:26688
    ds_read_b64_tr_b16 v[166:167], v122 offset:27328
    ds_read_b64_tr_b16 v[168:169], v122 offset:31808
    ds_read_b64_tr_b16 v[170:171], v122 offset:32448
    ds_read_b64_tr_b16 v[172:173], v122 offset:36928
    ds_read_b64_tr_b16 v[174:175], v122 offset:37568
    s_waitcnt lgkmcnt(0)
    ds_read_b64_tr_b16 v[176:177], v122 offset:21600
    ds_read_b64_tr_b16 v[178:179], v122 offset:22240
    ds_read_b64_tr_b16 v[180:181], v122 offset:26720
    ds_read_b64_tr_b16 v[182:183], v122 offset:27360
    ds_read_b64_tr_b16 v[184:185], v122 offset:31840
    ds_read_b64_tr_b16 v[186:187], v122 offset:32480
    ds_read_b64_tr_b16 v[188:189], v122 offset:36960
    ds_read_b64_tr_b16 v[190:191], v122 offset:37600
    s_waitcnt lgkmcnt(0)
    ds_read_b64_tr_b16 v[192:193], v122 offset:21632
    ds_read_b64_tr_b16 v[194:195], v122 offset:22272
    ds_read_b64_tr_b16 v[196:197], v122 offset:26752
    ds_read_b64_tr_b16 v[198:199], v122 offset:27392
    ds_read_b64_tr_b16 v[200:201], v122 offset:31872
    ds_read_b64_tr_b16 v[202:203], v122 offset:32512
    ds_read_b64_tr_b16 v[204:205], v122 offset:36992
    ds_read_b64_tr_b16 v[206:207], v122 offset:37632
    s_waitcnt lgkmcnt(0)
    s_branch L_pollO_w
L_pollO:
    s_bitcmp1_b32 s55, 0
    s_cbranch_scc0 L_pollO_k0
    buffer_load_dwordx4 v[48:51], v6, s[56:59], 0 offen offset:0 sc1
L_pollO_k0:
    s_bitcmp1_b32 s55, 1
    s_cbranch_scc0 L_pollO_k1
    buffer_load_dwordx4 v[52:55], v6, s[56:59], 0 offen offset:1024 sc1
L_pollO_k1:
    s_bitcmp1_b32 s55, 2
    s_cbranch_scc0 L_pollO_k2
    buffer_load_dwordx4 v[56:59], v6, s[56:59], 0 offen offset:2048 sc1
L_pollO_k2:
    s_bitcmp1_b32 s55, 3
    s_cbranch_scc0 L_pollO_k3
    buffer_load_dwordx4 v[60:63], v6, s[56:59], 0 offen offset:3072 sc1
L_pollO_k3:
L_pollO_w:
    s_waitcnt vmcnt(0)
    v_max3_u32 v124, v48, v49, v50
    v_max3_u32 v125, v52, v53, v54
    v_max3_u32 v126, v56, v57, v58
    v_max3_u32 v127, v60, v61, v62
    v_max_u32 v124, v124, v51
    v_max_u32 v125, v125, v55
    v_max_u32 v126, v126, v59
    v_max_u32 v127, v127, v63
    v_max3_u32 v43, v124, v125, v126
    v_max_u32 v43, v43, v127
    v_cmp_eq_u32 vcc, -1, v43
    s_cbranch_vccnz L_pollO_again
L_pollO_ok:
    v_add_f32 v12, v48, v52
    v_add_f32 v13, v49, v53
    v_add_f32 v14, v50, v54
    v_add_f32 v15, v51, v55
    v_add_f32 v16, v56, v60
    v_add_f32 v17, v57, v61
    v_add_f32 v18, v58, v62
    v_add_f32 v19, v59, v63
    v_permlane32_swap_b32 v12, v16
    v_permlane32_swap_b32 v13, v17
    v_permlane32_swap_b32 v14, v18
    v_permlane32_swap_b32 v15, v19
    v_add_f32 v12, v12, v16
    v_add_f32 v13, v13, v17
    v_add_f32 v14, v14, v18
    v_add_f32 v15, v15, v19
    v_cvt_pk_bf16_f32 v12, v12, v13
    v_cvt_pk_bf16_f32 v13, v14, v15
    ds_write_b64 v7, v[12:13] offset:4352
    s_cmp_eq_u32 s69, 0
    s_cbranch_scc1 L_noG2
    s_mov_b32 s64, 0
    buffer_load_dwordx4 v[48:51], v115, s[56:59], s64 offen sc1
    s_mov_b32 s64, 10240
    buffer_load_dwordx4 v[52:55], v115, s[56:59], s64 offen sc1
    s_mov_b32 s64, 20480
    buffer_load_dwordx4 v[56:59], v115, s[56:59], s64 offen sc1
    s_mov_b32 s64, 30720
    buffer_load_dwordx4 v[60:63], v115, s[56:59], s64 offen sc1
L_noG2:
    s_waitcnt lgkmcnt(0)
    s_mov_b32 exec_lo, 0x30003
    s_mov_b32 exec_hi, 0x30003
    ds_read_b128 v[208:211], v9 offset:4352
    ds_read_b128 v[212:215], v9 offset:4416
    ds_read_b128 v[216:219], v9 offset:4480
    ds_read_b128 v[220:223], v9 offset:4544
    s_mov_b32 exec_lo, 0xc000c
    s_mov_b32 exec_hi, 0xc000c
    ds_read_b128 v[224:227], v9 offset:4352
    ds_read_b128 v[228:231], v9 offset:4416
    ds_read_b128 v[232:235], v9 offset:4480
    ds_read_b128 v[236:239], v9 offset:4544
    s_mov_b32 exec_lo, 0x300030
    s_mov_b32 exec_hi, 0x300030
    ds_read_b128 v[240:243], v9 offset:4352
    ds_read_b128 v[244:247], v9 offset:4416
    ds_read_b128 v[248:251], v9 offset:4480
    ds_read_b128 v[252:255], v9 offset:4544
    s_mov_b64 exec, -1
    s_waitcnt lgkmcnt(11)
    v_mfma_f32_16x16x32_bf16 v[28:31], v[128:131], v[208:211], 0
    s_waitcnt lgkmcnt(10)
    v_mfma_f32_16x16x32_bf16 v[28:31], v[132:135], v[212:215], v[28:31]
    s_waitcnt lgkmcnt(9)
    v_mfma_f32_16x16x32_bf16 v[28:31], v[136:139], v[216:219], v[28:31]
    s_waitcnt lgkmcnt(8)
    v_mfma_f32_16x16x32_bf16 v[28:31], v[140:143], v[220:223], v[28:31]
    s_mov_b32 exec_lo, 0xc000c0
    s_mov_b32 exec_hi, 0xc000c0
    ds_read_b128 v[64:67], v9 offset:4352
    ds_read_b128 v[68:71], v9 offset:4416
    ds_read_b128 v[72:75], v9 offset:4480
    ds_read_b128 v[76:79], v9 offset:4544
    s_mov_b64 exec, -1
    s_waitcnt lgkmcnt(11)
    v_mfma_f32_16x16x32_bf16 v[28:31], v[144:147], v[224:227], v[28:31]
    s_waitcnt lgkmcnt(10)
    v_mfma_f32_16x16x32_bf16 v[28:31], v[148:151], v[228:231], v[28:31]
    s_waitcnt lgkmcnt(9)
    v_mfma_f32_16x16x32_bf16 v[28:31], v[152:155], v[232:235], v[28:31]
    s_waitcnt lgkmcnt(8)
    v_mfma_f32_16x16x32_bf16 v[28:31], v[156:159], v[236:239], v[28:31]
    s_mov_b32 exec_lo, 0x3000300
    s_mov_b32 exec_hi, 0x3000300
    ds_read_b128 v[80:83], v9 offset:4352
    ds_read_b128 v[84:87], v9 offset:4416
    ds_read_b128 v[88:91], v9 offset:4480
    ds_read_b128 v[92:95], v9 offset:4544
    s_mov_b64 exec, -1
    s_waitcnt lgkmcnt(11)
    v_mfma_f32_16x16x32_bf16 v[28:31], v[160:163], v[240:243], v[28:31]
    s_waitcnt lgkmcnt(10)
    v_mfma_f32_16x16x32_bf16 v[28:31], v[164:167], v[244:247], v[28:31]
    s_waitcnt lgkmcnt(9)
    v_mfma_f32_16x16x32_bf16 v[28:31], v[168:171], v[248:251], v[28:31]
    s_waitcnt lgkmcnt(8)
    v_mfma_f32_16x16x32_bf16 v[28:31], v[172:175], v[252:255], v[28:31]
    s_mov_b64 exec, -1
    s_waitcnt lgkmcnt(7)
    v_mfma_f32_16x16x32_bf16 v[28:31], v[176:179], v[64:67], v[28:31]
    s_waitcnt lgkmcnt(6)
    v_mfma_f32_16x16x32_bf16 v[28:31], v[180:183], v[68:71], v[28:31]
    s_waitcnt lgkmcnt(5)
    v_mfma_f32_16x16x32_bf16 v[28:31], v[184:187], v[72:75], v[28:31]
    s_waitcnt lgkmcnt(4)
    v_mfma_f32_16x16x32_bf16 v[28:31], v[188:191], v[76:79], v[28:31]
    s_mov_b64 exec, -1
    s_waitcnt lgkmcnt(3)
    v_mfma_f32_16x16x32_bf16 v[28:31], v[192:195], v[80:83], v[28:31]
    s_waitcnt lgkmcnt(2)
    v_mfma_f32_16x16x32_bf16 v[28:31], v[196:199], v[84:87], v[28:31]
    s_waitcnt lgkmcnt(1)
    v_mfma_f32_16x16x32_bf16 v[28:31], v[200:203], v[88:91], v[28:31]
    s_waitcnt lgkmcnt(0)
    v_mfma_f32_16x16x32_bf16 v[28:31], v[204:207], v[92:95], v[28:31]
    s_nop 7
    ds_write_b128 v113, v[28:31] offset:512
    s_waitcnt lgkmcnt(0)
    ds_read_b64 v[104:105], v118 offset:512
    ds_read_b64 v[108:109], v118 offset:1024
    s_waitcnt lgkmcnt(1)
    buffer_store_dwordx4 v[104:107], v114, s[56:59], s52 offen sc1
    s_mov_b64 exec, 0xffff
    s_waitcnt lgkmcnt(0)
    buffer_store_dwordx4 v[108:111], v114, s[56:59], s52 offen offset:1024 sc1
    s_mov_b64 exec, -1
    s_cmp_eq_u32 s69, 0
    s_cbranch_scc1 L_auxdone
    s_waitcnt vmcnt(2)
    v_cmp_ne_u64 vcc, s[100:101], v[50:51]
    v_cmp_ne_u64 s[70:71], s[100:101], v[54:55]
    s_or_b64 vcc, vcc, s[70:71]
    v_cmp_ne_u64 s[70:71], s[100:101], v[58:59]
    s_or_b64 vcc, vcc, s[70:71]
    v_cmp_ne_u64 s[70:71], s[100:101], v[62:63]
    s_or_b64 vcc, vcc, s[70:71]
    s_cbranch_vccnz L_pollG
L_pollG_ok:
    s_cmp_lg_u32 s2, 0
    s_cbranch_scc1 L_noEp
    v_mov_b32 v12, s100
    v_mov_b32 v13, s101
    s_mov_b32 s64, 0x6f000
    s_mov_b64 exec, 1
    buffer_store_dwordx2 v[12:13], off, s[56:59], s64
    s_mov_b64 exec, -1
L_noEp:
    v_add_f32 v48, v48, v52
    v_add_f32 v56, v56, v60
    v_add_f32 v49, v49, v53
    v_add_f32 v57, v57, v61
    v_add_f32 v44, v48, v56
    v_add_f32 v45, v49, v57
    s_nop 0
    v_add_f32_dpp v44, v44, v44 row_ror:8 row_mask:0xf bank_mask:0xf
    v_add_f32_dpp v45, v45, v45 row_ror:8 row_mask:0xf bank_mask:0xf
    v_mov_b32 v46, v44
    v_mov_b32 v47, v45
    s_nop 0
    v_permlane16_swap_b32 v44, v46
    v_permlane16_swap_b32 v45, v47
    v_add_f32 v44, v44, v46
    v_add_f32 v45, v45, v47
    v_mov_b32 v46, v44
    v_mov_b32 v47, v45
    s_nop 0
    v_permlane32_swap_b32 v44, v46
    v_permlane32_swap_b32 v45, v47
    v_add_f32 v44, v44, v46
    v_add_f32 v45, v45, v47
    v_cvt_pk_bf16_f32 v44, v44, v44
    v_and_b32 v44, 0xffff0000, v44
    v_cvt_pk_bf16_f32 v45, v45, v45
    v_and_b32 v45, 0xffff0000, v45
    v_mul_f32 v48, 0xbfb8aa3b, v44
    v_mul_f32 v49, 0xbfb8aa3b, v45
    v_exp_f32 v48, v48
    v_exp_f32 v49, v49
    s_nop 0
    v_add_f32 v48, 1.0, v48
    v_add_f32 v49, 1.0, v49
    v_rcp_f32 v48, v48
    v_rcp_f32 v49, v49
    s_nop 0
    v_mul_f32 v116, v44, v48
    v_mul_f32 v117, v45, v49
    v_cvt_pk_bf16_f32 v116, v116, v116
    v_and_b32 v116, 0xffff0000, v116
    v_cvt_pk_bf16_f32 v117, v117, v117
    v_and_b32 v117, 0xffff0000, v117
    s_waitcnt vmcnt(0)
    s_mov_b32 s64, 458752
    buffer_load_dwordx4 v[128:131], v115, s[56:59], s64 offen sc1
    s_mov_b32 s64, 468992
    buffer_load_dwordx4 v[132:135], v115, s[56:59], s64 offen sc1
    s_mov_b32 s64, 479232
    buffer_load_dwordx4 v[136:139], v115, s[56:59], s64 offen sc1
    s_mov_b32 s64, 489472
    buffer_load_dwordx4 v[140:143], v115, s[56:59], s64 offen sc1
    s_sleep 4
L_pollY:
    s_mov_b32 s64, 458752
    buffer_load_dwordx4 v[144:147], v115, s[56:59], s64 offen sc1
    s_mov_b32 s64, 468992
    buffer_load_dwordx4 v[148:151], v115, s[56:59], s64 offen sc1
    s_mov_b32 s64, 479232
    buffer_load_dwordx4 v[152:155], v115, s[56:59], s64 offen sc1
    s_mov_b32 s64, 489472
    buffer_load_dwordx4 v[156:159], v115, s[56:59], s64 offen sc1
    s_waitcnt vmcnt(4)
    v_cmp_ne_u64 vcc, s[100:101], v[130:131]
    v_cmp_ne_u64 s[70:71], s[100:101], v[134:135]
    s_or_b64 vcc, vcc, s[70:71]
    v_cmp_ne_u64 s[70:71], s[100:101], v[138:139]
    s_or_b64 vcc, vcc, s[70:71]
    v_cmp_ne_u64 s[70:71], s[100:101], v[142:143]
    s_or_b64 vcc, vcc, s[70:71]
    s_cbranch_vccz L_pollY_0
    s_mov_b32 s64, 458752
    buffer_load_dwordx4 v[128:131], v115, s[56:59], s64 offen sc1
    s_mov_b32 s64, 468992
    buffer_load_dwordx4 v[132:135], v115, s[56:59], s64 offen sc1
    s_mov_b32 s64, 479232
    buffer_load_dwordx4 v[136:139], v115, s[56:59], s64 offen sc1
    s_mov_b32 s64, 489472
    buffer_load_dwordx4 v[140:143], v115, s[56:59], s64 offen sc1
    s_waitcnt vmcnt(4)
    v_cmp_ne_u64 vcc, s[100:101], v[146:147]
    v_cmp_ne_u64 s[70:71], s[100:101], v[150:151]
    s_or_b64 vcc, vcc, s[70:71]
    v_cmp_ne_u64 s[70:71], s[100:101], v[154:155]
    s_or_b64 vcc, vcc, s[70:71]
    v_cmp_ne_u64 s[70:71], s[100:101], v[158:159]
    s_or_b64 vcc, vcc, s[70:71]
    s_cbranch_vccz L_pollY_1
    s_sub_u32 s98, s98, 1
    s_cbranch_scc0 L_pollY
L_pollY_1:
    v_add_f32 v144, v144, v148
    v_add_f32 v152, v152, v156
    v_add_f32 v145, v145, v149
    v_add_f32 v153, v153, v157
    v_add_f32 v44, v144, v152
    v_add_f32 v45, v145, v153
    s_branch L_pollY_ok
L_pollY_0:
    v_add_f32 v128, v128, v132
    v_add_f32 v136, v136, v140
    v_add_f32 v129, v129, v133
    v_add_f32 v137, v137, v141
    v_add_f32 v44, v128, v136
    v_add_f32 v45, v129, v137
L_pollY_ok:
    s_nop 0
    v_add_f32_dpp v44, v44, v44 row_ror:8 row_mask:0xf bank_mask:0xf
    v_add_f32_dpp v45, v45, v45 row_ror:8 row_mask:0xf bank_mask:0xf
    v_mov_b32 v46, v44
    v_mov_b32 v47, v45
    s_nop 0
    v_permlane16_swap_b32 v44, v46
    v_permlane16_swap_b32 v45, v47
    v_add_f32 v44, v44, v46
    v_add_f32 v45, v45, v47
    v_mov_b32 v46, v44
    v_mov_b32 v47, v45
    s_nop 0
    v_permlane32_swap_b32 v44, v46
    v_permlane32_swap_b32 v45, v47
    v_add_f32 v44, v44, v46
    v_add_f32 v45, v45, v47
    v_cvt_pk_bf16_f32 v44, v44, v44
    v_and_b32 v44, 0xffff0000, v44
    v_cvt_pk_bf16_f32 v45, v45, v45
    v_and_b32 v45, 0xffff0000, v45
    v_mul_f32 v44, v44, v116
    v_mul_f32 v45, v45, v117
    v_cvt_pk_bf16_f32 v44, v44, v44
    v_and_b32 v44, 0xffff0000, v44
    v_cvt_pk_bf16_f32 v45, v45, v45
    v_and_b32 v45, 0xffff0000, v45
    v_add_f32 v44, v44, v120
    v_add_f32 v45, v45, v121
    s_mov_b64 exec, 0xff
    v_cvt_pk_bf16_f32 v44, v44, v45
    buffer_store_dword v44, v42, s[48:51], 0 offen
    s_branch L_auxdone
L_far_q:
    buffer_store_dwordx4 v[100:103], v10, s[56:59], 0 offen sc1
    buffer_store_dwordx4 v[104:107], v10, s[56:59], 0 offen offset:512 sc1
    s_branch L_near_q
L_far_pa:
    buffer_store_dwordx4 v[128:131], v6, s[56:59], 0 offen offset:0 sc1
    buffer_store_dwordx4 v[132:135], v6, s[56:59], 0 offen offset:256 sc1
    buffer_store_dwordx4 v[136:139], v6, s[56:59], 0 offen offset:512 sc1
    buffer_store_dwordx4 v[140:143], v6, s[56:59], 0 offen offset:768 sc1
    buffer_store_dwordx4 v[144:147], v6, s[56:59], 0 offen offset:1024 sc1
    buffer_store_dwordx4 v[148:151], v6, s[56:59], 0 offen offset:1280 sc1
    buffer_store_dwordx4 v[152:155], v6, s[56:59], 0 offen offset:1536 sc1
    buffer_store_dwordx4 v[156:159], v6, s[56:59], 0 offen offset:1792 sc1
    s_branch L_near_pa
L_far_ml:
    buffer_store_dwordx4 v[28:31], off, s[56:59], s54 sc1
    s_branch L_near_ml
L_far_o:
    buffer_store_dwordx4 v[20:23], v4, s[56:59], 0 offen sc1
    s_branch L_near_o
L_pollG:
    s_mov_b32 s64, 0
    buffer_load_dwordx4 v[48:51], v115, s[56:59], s64 offen sc1
    s_mov_b32 s64, 10240
    buffer_load_dwordx4 v[52:55], v115, s[56:59], s64 offen sc1
    s_mov_b32 s64, 20480
    buffer_load_dwordx4 v[56:59], v115, s[56:59], s64 offen sc1
    s_mov_b32 s64, 30720
    buffer_load_dwordx4 v[60:63], v115, s[56:59], s64 offen sc1
    s_waitcnt vmcnt(0)
    v_cmp_ne_u64 vcc, s[100:101], v[50:51]
    v_cmp_ne_u64 s[70:71], s[100:101], v[54:55]
    s_or_b64 vcc, vcc, s[70:71]
    v_cmp_ne_u64 s[70:71], s[100:101], v[58:59]
    s_or_b64 vcc, vcc, s[70:71]
    v_cmp_ne_u64 s[70:71], s[100:101], v[62:63]
    s_or_b64 vcc, vcc, s[70:71]
    s_cbranch_vccz L_pollG_ok
    s_sub_u32 s98, s98, 1
    s_cbranch_scc0 L_pollG
    s_branch L_pollG_ok
L_pollO_again:
    s_mov_b32 s55, 0
    v_cmp_eq_u32 vcc, -1, v124
    s_cmp_lg_u64 vcc, 0
    s_cselect_b32 s70, 1, 0
    s_or_b32 s55, s55, s70
    v_cmp_eq_u32 vcc, -1, v125
    s_cmp_lg_u64 vcc, 0
    s_cselect_b32 s70, 2, 0
    s_or_b32 s55, s55, s70
    v_cmp_eq_u32 vcc, -1, v126
    s_cmp_lg_u64 vcc, 0
    s_cselect_b32 s70, 4, 0
    s_or_b32 s55, s55, s70
    v_cmp_eq_u32 vcc, -1, v127
    s_cmp_lg_u64 vcc, 0
    s_cselect_b32 s70, 8, 0
    s_or_b32 s55, s55, s70
    s_sub_u32 s98, s98, 1
    s_cbranch_scc0 L_pollO
    s_branch L_pollO_ok
L_auxdone:
L_end:
    s_endpgm
L_srest:
    s_add_u32 s36, s8, s65
    s_addc_u32 s37, s9, 0
    s_and_b32 s37, s37, 0xffff
    v_lshrrev_b32 v30, 4, v0
    v_and_b32 v31, 15, v0
    v_and_b32 v16, 1, v31
    v_lshlrev_b32 v16, 4, v16
    v_mov_b32 v17, 0xffff
    v_lshlrev_b32 v16, v16, v17
    v_lshrrev_b32 v17, 1, v31
    v_cmp_eq_u32 vcc, 0, v17
    s_nop 1
    v_cndmask_b32 v4, 0, v16, vcc
    v_cmp_eq_u32 vcc, 1, v17
    s_nop 1
    v_cndmask_b32 v5, 0, v16, vcc
    v_cmp_eq_u32 vcc, 2, v17
    s_nop 1
    v_cndmask_b32 v6, 0, v16, vcc
    v_cmp_eq_u32 vcc, 3, v17
    s_nop 1
    v_cndmask_b32 v7, 0, v16, vcc
    s_mov_b32 s40, 0xcccccccc
    s_mov_b32 s41, 0xcccccccc
    s_mov_b32 s42, 0xaaaaaaaa
    s_mov_b32 s43, 0xaaaaaaaa
    v_lshlrev_b32 v3, 5, v31
    v_lshl_add_u32 v3, v30, 4, v3
    s_lshl_b32 s65, s64, 9
    v_add_u32 v3, s65, v3
    v_lshlrev_b32 v2, 4, v31
    v_mov_b32 v24, 0xff800000
    v_mov_b32 v25, 0
    s_lshl_b32 s65, s64, 12
    v_lshl_add_u32 v29, v0, 2, s65
    v_mov_b32 v28, v29
    v_mov_b32 v16, 0
    v_mov_b32 v17, 0
    v_mov_b32 v18, 0
    v_mov_b32 v19, 0
    s_mov_b32 s71, 0x3fb8aa3b
    s_mov_b64 vcc, 0
    s_waitcnt vmcnt(0)
    buffer_load_dwordx4 v[136:139], v1, s[32:35], s44 offen offset:2048 nt
    buffer_load_dwordx4 v[140:143], v1, s[32:35], s44 offen offset:3072 nt
    buffer_load_dwordx4 v[144:147], v1, s[32:35], s45 offen offset:0 nt
    buffer_load_dwordx4 v[148:151], v1, s[32:35], s45 offen offset:1024 nt
    buffer_load_dwordx4 v[152:155], v1, s[32:35], s45 offen offset:2048 nt
    buffer_load_dwordx4 v[156:159], v1, s[32:35], s45 offen offset:3072 nt
    s_waitcnt vmcnt(5)
    buffer_load_dwordx4 v[160:163], v1, s[32:35], s46 offen offset:0 nt
    s_waitcnt vmcnt(5)
    buffer_load_dwordx4 v[164:167], v1, s[32:35], s46 offen offset:1024 nt
    s_waitcnt vmcnt(5)
    buffer_load_dwordx4 v[168:171], v1, s[32:35], s46 offen offset:2048 nt
    s_waitcnt vmcnt(5)
    buffer_load_dwordx4 v[172:175], v1, s[32:35], s46 offen offset:3072 nt
    s_waitcnt vmcnt(5)
    buffer_load_dwordx4 v[176:179], v1, s[32:35], s47 offen offset:0 nt
    s_waitcnt vmcnt(5)
    buffer_load_dwordx4 v[180:183], v1, s[32:35], s47 offen offset:1024 nt
    s_waitcnt vmcnt(5)
    buffer_load_dwordx4 v[184:187], v1, s[32:35], s47 offen offset:2048 nt
    s_waitcnt vmcnt(5)
    buffer_load_dwordx4 v[188:191], v1, s[32:35], s47 offen offset:3072 nt
    s_waitcnt vmcnt(5)
    s_add_u32 s44, s44, 0x40000
    s_add_u32 s45, s45, 0x40000
    s_add_u32 s46, s46, 0x40000
    s_add_u32 s47, s47, 0x40000
    buffer_load_dwordx4 v[192:195], v1, s[32:35], s44 offen offset:0 nt
    s_waitcnt vmcnt(5)
    buffer_load_dwordx4 v[196:199], v1, s[32:35], s44 offen offset:1024 nt
    s_waitcnt vmcnt(5)
    buffer_load_dwordx4 v[200:203], v1, s[32:35], s44 offen offset:2048 nt
    s_waitcnt vmcnt(5)
    buffer_load_dwordx4 v[204:207], v1, s[32:35], s44 offen offset:3072 nt
    s_waitcnt vmcnt(5)
    buffer_load_dwordx4 v[208:211], v1, s[32:35], s45 offen offset:0 nt
    s_waitcnt vmcnt(5)
    buffer_load_dwordx4 v[212:215], v1, s[32:35], s45 offen offset:1024 nt
    s_waitcnt vmcnt(5)
    buffer_load_dwordx4 v[216:219], v1, s[32:35], s45 offen offset:2048 nt
    s_waitcnt vmcnt(5)
    buffer_load_dwordx4 v[220:223], v1, s[32:35], s45 offen offset:3072 nt
    s_waitcnt vmcnt(5)
    buffer_load_dwordx4 v[224:227], v1, s[32:35], s46 offen offset:0 nt
    s_waitcnt vmcnt(5)
    buffer_load_dwordx4 v[228:231], v1, s[32:35], s46 offen offset:1024 nt
    s_waitcnt vmcnt(5)
    buffer_load_dwordx4 v[232:235], v1, s[32:35], s46 offen offset:2048 nt
    s_waitcnt vmcnt(5)
    buffer_load_dwordx4 v[236:239], v1, s[32:35], s46 offen offset:3072 nt
    s_waitcnt vmcnt(5)
    buffer_load_dwordx4 v[240:243], v1, s[32:35], s47 offen offset:0 nt
    s_waitcnt vmcnt(5)
    buffer_load_dwordx4 v[244:247], v1, s[32:35], s47 offen offset:1024 nt
    s_waitcnt vmcnt(5)
    buffer_load_dwordx4 v[248:251], v1, s[32:35], s47 offen offset:2048 nt
    s_waitcnt vmcnt(5)
    buffer_load_dwordx4 v[252:255], v1, s[32:35], s47 offen offset:3072 nt
    s_barrier
    ds_read_b128 v[20:23], v2 offset:0
    v_mov_b32 v30, 0
    ds_read_b32 v30, v30 offset:4168
    s_memrealtime s[54:55]
    s_add_u32 s68, s68, 562
    s_waitcnt lgkmcnt(0)
    v_readfirstlane_b32 s53, v30
    s_add_u32 s68, s68, s53
    s_mov_b32 s70, 4
L_kloop:
    s_add_u32 s44, s44, 0x40000
    s_add_u32 s45, s45, 0x40000
    s_add_u32 s46, s46, 0x40000
    s_add_u32 s47, s47, 0x40000
    s_cmp_lt_u32 s44, 0x200000
    s_cbranch_scc1 L_s1
    s_mov_b32 s32, s36
    s_mov_b32 s33, s37
    s_sub_u32 s44, s44, 0x200000
    s_sub_u32 s45, s45, 0x200000
    s_sub_u32 s46, s46, 0x200000
    s_sub_u32 s47, s47, 0x200000
L_s1:
    s_waitcnt lgkmcnt(0)
    s_add_u32 s68, s68, 113
    s_sub_u32 s53, s54, s68
    s_cmp_gt_i32 s53, 85
    s_cselect_b64 vcc, -1, 0
    s_cmp_gt_i32 s53, 0
    v_dot2_f32_bf16 v32, v128, v20, 0
    v_dot2_f32_bf16 v32, v129, v21, v32
    v_dot2_f32_bf16 v32, v130, v22, v32
    v_dot2_f32_bf16 v32, v131, v23, v32
    s_waitcnt vmcnt(7)
    s_cbranch_vccnz L_s2
    s_waitcnt vmcnt(5)
    s_cbranch_scc1 L_s2
    s_waitcnt vmcnt(4)
L_s2:
    buffer_load_dwordx4 v[128:131], v1, s[32:35], s44 offen offset:0 nt
    v_dot2_f32_bf16 v33, v132, v20, 0
    v_dot2_f32_bf16 v33, v133, v21, v33
    v_dot2_f32_bf16 v33, v134, v22, v33
    v_dot2_f32_bf16 v33, v135, v23, v33
    s_waitcnt vmcnt(7)
    s_cbranch_vccnz L_s3
    s_waitcnt vmcnt(5)
    s_cbranch_scc1 L_s3
    s_waitcnt vmcnt(4)
L_s3:
    buffer_load_dwordx4 v[132:135], v1, s[32:35], s44 offen offset:1024 nt
    v_dot2_f32_bf16 v34, v136, v20, 0
    v_dot2_f32_bf16 v34, v137, v21, v34
    v_dot2_f32_bf16 v34, v138, v22, v34
    v_dot2_f32_bf16 v34, v139, v23, v34
    s_waitcnt vmcnt(7)
    s_cbranch_vccnz L_s4
    s_waitcnt vmcnt(5)
    s_cbranch_scc1 L_s4
    s_waitcnt vmcnt(4)
L_s4:
    buffer_load_dwordx4 v[136:139], v1, s[32:35], s44 offen offset:2048 nt
    v_dot2_f32_bf16 v35, v140, v20, 0
    v_dot2_f32_bf16 v35, v141, v21, v35
    v_dot2_f32_bf16 v35, v142, v22, v35
    v_dot2_f32_bf16 v35, v143, v23, v35
    s_waitcnt vmcnt(7)
    s_cbranch_vccnz L_s5
    s_waitcnt vmcnt(5)
    s_cbranch_scc1 L_s5
    s_waitcnt vmcnt(4)
L_s5:
    buffer_load_dwordx4 v[140:143], v1, s[32:35], s44 offen offset:3072 nt
    v_dot2_f32_bf16 v36, v144, v20, 0
    v_dot2_f32_bf16 v36, v145, v21, v36
    v_dot2_f32_bf16 v36, v146, v22, v36
    v_dot2_f32_bf16 v36, v147, v23, v36
    s_waitcnt vmcnt(7)
    s_cbranch_vccnz L_s6
    s_waitcnt vmcnt(5)
    s_cbranch_scc1 L_s6
    s_waitcnt vmcnt(4)
L_s6:
    buffer_load_dwordx4 v[144:147], v1, s[32:35], s45 offen offset:0 nt
    v_dot2_f32_bf16 v37, v148, v20, 0
    v_dot2_f32_bf16 v37, v149, v21, v37
    v_dot2_f32_bf16 v37, v150, v22, v37
    v_dot2_f32_bf16 v37, v151, v23, v37
    s_waitcnt vmcnt(7)
    s_cbranch_vccnz L_s7
    s_waitcnt vmcnt(5)
    s_cbranch_scc1 L_s7
    s_waitcnt vmcnt(4)
L_s7:
    buffer_load_dwordx4 v[148:151], v1, s[32:35], s45 offen offset:1024 nt
    v_dot2_f32_bf16 v38, v152, v20, 0
    v_dot2_f32_bf16 v38, v153, v21, v38
    v_dot2_f32_bf16 v38, v154, v22, v38
    v_dot2_f32_bf16 v38, v155, v23, v38
    s_waitcnt vmcnt(7)
    s_cbranch_vccnz L_s8
    s_waitcnt vmcnt(5)
    s_cbranch_scc1 L_s8
    s_waitcnt vmcnt(4)
L_s8:
    buffer_load_dwordx4 v[152:155], v1, s[32:35], s45 offen offset:2048 nt
    v_dot2_f32_bf16 v39, v156, v20, 0
    v_dot2_f32_bf16 v39, v157, v21, v39
    v_dot2_f32_bf16 v39, v158, v22, v39
    v_dot2_f32_bf16 v39, v159, v23, v39
    s_waitcnt vmcnt(7)
    s_cbranch_vccnz L_s9
    s_waitcnt vmcnt(5)
    s_cbranch_scc1 L_s9
    s_waitcnt vmcnt(4)
L_s9:
    s_memrealtime s[54:55]
    buffer_load_dwordx4 v[156:159], v1, s[32:35], s45 offen offset:3072 nt
    s_waitcnt lgkmcnt(0)
    s_add_u32 s68, s68, 113
    s_sub_u32 s53, s54, s68
    s_cmp_gt_i32 s53, 85
    s_cselect_b64 vcc, -1, 0
    s_cmp_gt_i32 s53, 0
    v_dot2_f32_bf16 v40, v160, v20, 0
    v_dot2_f32_bf16 v40, v161, v21, v40
    v_dot2_f32_bf16 v40, v162, v22, v40
    v_dot2_f32_bf16 v40, v163, v23, v40
    s_waitcnt vmcnt(7)
    s_cbranch_vccnz L_s10
    s_waitcnt vmcnt(5)
    s_cbranch_scc1 L_s10
    s_waitcnt vmcnt(4)
L_s10:
    buffer_load_dwordx4 v[160:163], v1, s[32:35], s46 offen offset:0 nt
    v_dot2_f32_bf16 v41, v164, v20, 0
    v_dot2_f32_bf16 v41, v165, v21, v41
    v_dot2_f32_bf16 v41, v166, v22, v41
    v_dot2_f32_bf16 v41, v167, v23, v41
    s_waitcnt vmcnt(7)
    s_cbranch_vccnz L_s11
    s_waitcnt vmcnt(5)
    s_cbranch_scc1 L_s11
    s_waitcnt vmcnt(4)
L_s11:
    buffer_load_dwordx4 v[164:167], v1, s[32:35], s46 offen offset:1024 nt
    v_dot2_f32_bf16 v42, v168, v20, 0
    v_dot2_f32_bf16 v42, v169, v21, v42
    v_dot2_f32_bf16 v42, v170, v22, v42
    v_dot2_f32_bf16 v42, v171, v23, v42
    s_waitcnt vmcnt(7)
    s_cbranch_vccnz L_s12
    s_waitcnt vmcnt(5)
    s_cbranch_scc1 L_s12
    s_waitcnt vmcnt(4)
L_s12:
    buffer_load_dwordx4 v[168:171], v1, s[32:35], s46 offen offset:2048 nt
    v_dot2_f32_bf16 v43, v172, v20, 0
    v_dot2_f32_bf16 v43, v173, v21, v43
    v_dot2_f32_bf16 v43, v174, v22, v43
    v_dot2_f32_bf16 v43, v175, v23, v43
    s_waitcnt vmcnt(7)
    s_cbranch_vccnz L_s13
    s_waitcnt vmcnt(5)
    s_cbranch_scc1 L_s13
    s_waitcnt vmcnt(4)
L_s13:
    buffer_load_dwordx4 v[172:175], v1, s[32:35], s46 offen offset:3072 nt
    v_dot2_f32_bf16 v44, v176, v20, 0
    v_dot2_f32_bf16 v44, v177, v21, v44
    v_dot2_f32_bf16 v44, v178, v22, v44
    v_dot2_f32_bf16 v44, v179, v23, v44
    s_waitcnt vmcnt(7)
    s_cbranch_vccnz L_s14
    s_waitcnt vmcnt(5)
    s_cbranch_scc1 L_s14
    s_waitcnt vmcnt(4)
L_s14:
    buffer_load_dwordx4 v[176:179], v1, s[32:35], s47 offen offset:0 nt
    v_dot2_f32_bf16 v45, v180, v20, 0
    v_dot2_f32_bf16 v45, v181, v21, v45
    v_dot2_f32_bf16 v45, v182, v22, v45
    v_dot2_f32_bf16 v45, v183, v23, v45
    s_waitcnt vmcnt(7)
    s_cbranch_vccnz L_s15
    s_waitcnt vmcnt(5)
    s_cbranch_scc1 L_s15
    s_waitcnt vmcnt(4)
L_s15:
    buffer_load_dwordx4 v[180:183], v1, s[32:35], s47 offen offset:1024 nt
    v_dot2_f32_bf16 v46, v184, v20, 0
    v_dot2_f32_bf16 v46, v185, v21, v46
    v_dot2_f32_bf16 v46, v186, v22, v46
    v_dot2_f32_bf16 v46, v187, v23, v46
    s_waitcnt vmcnt(7)
    s_cbranch_vccnz L_s16
    s_waitcnt vmcnt(5)
    s_cbranch_scc1 L_s16
    s_waitcnt vmcnt(4)
L_s16:
    buffer_load_dwordx4 v[184:187], v1, s[32:35], s47 offen offset:2048 nt
    v_dot2_f32_bf16 v47, v188, v20, 0
    v_dot2_f32_bf16 v47, v189, v21, v47
    v_dot2_f32_bf16 v47, v190, v22, v47
    v_dot2_f32_bf16 v47, v191, v23, v47
    s_waitcnt vmcnt(7)
    s_cbranch_vccnz L_s17
    s_waitcnt vmcnt(5)
    s_cbranch_scc1 L_s17
    s_waitcnt vmcnt(4)
L_s17:
    s_memrealtime s[54:55]
    buffer_load_dwordx4 v[188:191], v1, s[32:35], s47 offen offset:3072 nt
    v_add_f32_dpp v32, v32, v32 row_ror:8 row_mask:0xf bank_mask:0x3
    v_add_f32_dpp v32, v40, v40 row_ror:8 row_mask:0xf bank_mask:0xc
    v_add_f32_dpp v33, v33, v33 row_ror:8 row_mask:0xf bank_mask:0x3
    v_add_f32_dpp v33, v41, v41 row_ror:8 row_mask:0xf bank_mask:0xc
    v_add_f32_dpp v34, v34, v34 row_ror:8 row_mask:0xf bank_mask:0x3
    v_add_f32_dpp v34, v42, v42 row_ror:8 row_mask:0xf bank_mask:0xc
    v_add_f32_dpp v35, v35, v35 row_ror:8 row_mask:0xf bank_mask:0x3
    v_add_f32_dpp v35, v43, v43 row_ror:8 row_mask:0xf bank_mask:0xc
    v_add_f32_dpp v36, v36, v36 row_ror:8 row_mask:0xf bank_mask:0x3
    v_add_f32_dpp v36, v44, v44 row_ror:8 row_mask:0xf bank_mask:0xc
    v_add_f32_dpp v37, v37, v37 row_ror:8 row_mask:0xf bank_mask:0x3
    v_add_f32_dpp v37, v45, v45 row_ror:8 row_mask:0xf bank_mask:0xc
    v_add_f32_dpp v38, v38, v38 row_ror:8 row_mask:0xf bank_mask:0x3
    v_add_f32_dpp v38, v46, v46 row_ror:8 row_mask:0xf bank_mask:0xc
    v_add_f32_dpp v39, v39, v39 row_ror:8 row_mask:0xf bank_mask:0x3
    v_add_f32_dpp v39, v47, v47 row_ror:8 row_mask:0xf bank_mask:0xc
    v_add_f32_dpp v32, v32, v32 row_shl:4 row_mask:0xf bank_mask:0x5
    v_add_f32_dpp v32, v36, v36 row_shr:4 row_mask:0xf bank_mask:0xa
    v_add_f32_dpp v33, v33, v33 row_shl:4 row_mask:0xf bank_mask:0x5
    v_add_f32_dpp v33, v37, v37 row_shr:4 row_mask:0xf bank_mask:0xa
    v_add_f32_dpp v34, v34, v34 row_shl:4 row_mask:0xf bank_mask:0x5
    v_add_f32_dpp v34, v38, v38 row_shr:4 row_mask:0xf bank_mask:0xa
    v_add_f32_dpp v35, v35, v35 row_shl:4 row_mask:0xf bank_mask:0x5
    v_add_f32_dpp v35, v39, v39 row_shr:4 row_mask:0xf bank_mask:0xa
    s_nop 0
    v_add_f32_dpp v32, v32, v32 quad_perm:[2,3,0,1] row_mask:0xf bank_mask:0xf
    v_add_f32_dpp v33, v33, v33 quad_perm:[2,3,0,1] row_mask:0xf bank_mask:0xf
    v_add_f32_dpp v34, v34, v34 quad_perm:[2,3,0,1] row_mask:0xf bank_mask:0xf
    v_add_f32_dpp v35, v35, v35 quad_perm:[2,3,0,1] row_mask:0xf bank_mask:0xf
    v_cndmask_b32 v32, v32, v34, s[40:41]
    v_cndmask_b32 v33, v33, v35, s[40:41]
    s_nop 0
    v_add_f32_dpp v32, v32, v32 quad_perm:[1,0,3,2] row_mask:0xf bank_mask:0xf
    v_add_f32_dpp v33, v33, v33 quad_perm:[1,0,3,2] row_mask:0xf bank_mask:0xf
    v_cndmask_b32 v32, v32, v33, s[42:43]
    v_cvt_pk_bf16_f32 v32, v32, v32
    v_and_b32 v32, 0xffff0000, v32
    v_mul_f32 v32, 0x3db504f3, v32
    v_cvt_pk_bf16_f32 v32, v32, v32
    v_and_b32 v32, 0xffff0000, v32
    v_max_f32 v24, v24, v32
    ds_write_b32 v28, v32 offset:5120
    v_add_u32 v28, 256, v28
    s_add_u32 s44, s44, 0x40000
    s_add_u32 s45, s45, 0x40000
    s_add_u32 s46, s46, 0x40000
    s_add_u32 s47, s47, 0x40000
    s_cmp_lt_u32 s44, 0x200000
    s_cbranch_scc1 L_s18
    s_mov_b32 s32, s36
    s_mov_b32 s33, s37
    s_sub_u32 s44, s44, 0x200000
    s_sub_u32 s45, s45, 0x200000
    s_sub_u32 s46, s46, 0x200000
    s_sub_u32 s47, s47, 0x200000
L_s18:
    s_waitcnt lgkmcnt(0)
    s_add_u32 s68, s68, 113
    s_sub_u32 s53, s54, s68
    s_cmp_gt_i32 s53, 85
    s_cselect_b64 vcc, -1, 0
    s_cmp_gt_i32 s53, 0
    v_dot2_f32_bf16 v32, v192, v20, 0
    v_dot2_f32_bf16 v32, v193, v21, v32
    v_dot2_f32_bf16 v32, v194, v22, v32
    v_dot2_f32_bf16 v32, v195, v23, v32
    s_waitcnt vmcnt(7)
    s_cbranch_vccnz L_s19
    s_waitcnt vmcnt(5)
    s_cbranch_scc1 L_s19
    s_waitcnt vmcnt(4)
L_s19:
    buffer_load_dwordx4 v[192:195], v1, s[32:35], s44 offen offset:0 nt
    v_dot2_f32_bf16 v33, v196, v20, 0
    v_dot2_f32_bf16 v33, v197, v21, v33
    v_dot2_f32_bf16 v33, v198, v22, v33
    v_dot2_f32_bf16 v33, v199, v23, v33
    s_waitcnt vmcnt(7)
    s_cbranch_vccnz L_s20
    s_waitcnt vmcnt(5)
    s_cbranch_scc1 L_s20
    s_waitcnt vmcnt(4)
L_s20:
    buffer_load_dwordx4 v[196:199], v1, s[32:35], s44 offen offset:1024 nt
    v_dot2_f32_bf16 v34, v200, v20, 0
    v_dot2_f32_bf16 v34, v201, v21, v34
    v_dot2_f32_bf16 v34, v202, v22, v34
    v_dot2_f32_bf16 v34, v203, v23, v34
    s_waitcnt vmcnt(7)
    s_cbranch_vccnz L_s21
    s_waitcnt vmcnt(5)
    s_cbranch_scc1 L_s21
    s_waitcnt vmcnt(4)
L_s21:
    buffer_load_dwordx4 v[200:203], v1, s[32:35], s44 offen offset:2048 nt
    v_dot2_f32_bf16 v35, v204, v20, 0
    v_dot2_f32_bf16 v35, v205, v21, v35
    v_dot2_f32_bf16 v35, v206, v22, v35
    v_dot2_f32_bf16 v35, v207, v23, v35
    s_waitcnt vmcnt(7)
    s_cbranch_vccnz L_s22
    s_waitcnt vmcnt(5)
    s_cbranch_scc1 L_s22
    s_waitcnt vmcnt(4)
L_s22:
    buffer_load_dwordx4 v[204:207], v1, s[32:35], s44 offen offset:3072 nt
    v_dot2_f32_bf16 v36, v208, v20, 0
    v_dot2_f32_bf16 v36, v209, v21, v36
    v_dot2_f32_bf16 v36, v210, v22, v36
    v_dot2_f32_bf16 v36, v211, v23, v36
    s_waitcnt vmcnt(7)
    s_cbranch_vccnz L_s23
    s_waitcnt vmcnt(5)
    s_cbranch_scc1 L_s23
    s_waitcnt vmcnt(4)
L_s23:
    buffer_load_dwordx4 v[208:211], v1, s[32:35], s45 offen offset:0 nt
    v_dot2_f32_bf16 v37, v212, v20, 0
    v_dot2_f32_bf16 v37, v213, v21, v37
    v_dot2_f32_bf16 v37, v214, v22, v37
    v_dot2_f32_bf16 v37, v215, v23, v37
    s_waitcnt vmcnt(7)
    s_cbranch_vccnz L_s24
    s_waitcnt vmcnt(5)
    s_cbranch_scc1 L_s24
    s_waitcnt vmcnt(4)
L_s24:
    buffer_load_dwordx4 v[212:215], v1, s[32:35], s45 offen offset:1024 nt
    v_dot2_f32_bf16 v38, v216, v20, 0
    v_dot2_f32_bf16 v38, v217, v21, v38
    v_dot2_f32_bf16 v38, v218, v22, v38
    v_dot2_f32_bf16 v38, v219, v23, v38
    s_waitcnt vmcnt(7)
    s_cbranch_vccnz L_s25
    s_waitcnt vmcnt(5)
    s_cbranch_scc1 L_s25
    s_waitcnt vmcnt(4)
L_s25:
    buffer_load_dwordx4 v[216:219], v1, s[32:35], s45 offen offset:2048 nt
    v_dot2_f32_bf16 v39, v220, v20, 0
    v_dot2_f32_bf16 v39, v221, v21, v39
    v_dot2_f32_bf16 v39, v222, v22, v39
    v_dot2_f32_bf16 v39, v223, v23, v39
    s_waitcnt vmcnt(7)
    s_cbranch_vccnz L_s26
    s_waitcnt vmcnt(5)
    s_cbranch_scc1 L_s26
    s_waitcnt vmcnt(4)
L_s26:
    s_memrealtime s[54:55]
    buffer_load_dwordx4 v[220:223], v1, s[32:35], s45 offen offset:3072 nt
    s_waitcnt lgkmcnt(0)
    s_add_u32 s68, s68, 113
    s_sub_u32 s53, s54, s68
    s_cmp_gt_i32 s53, 85
    s_cselect_b64 vcc, -1, 0
    s_cmp_gt_i32 s53, 0
    v_dot2_f32_bf16 v40, v224, v20, 0
    v_dot2_f32_bf16 v40, v225, v21, v40
    v_dot2_f32_bf16 v40, v226, v22, v40
    v_dot2_f32_bf16 v40, v227, v23, v40
    s_waitcnt vmcnt(7)
    s_cbranch_vccnz L_s27
    s_waitcnt vmcnt(5)
    s_cbranch_scc1 L_s27
    s_waitcnt vmcnt(4)
L_s27:
    buffer_load_dwordx4 v[224:227], v1, s[32:35], s46 offen offset:0 nt
    v_dot2_f32_bf16 v41, v228, v20, 0
    v_dot2_f32_bf16 v41, v229, v21, v41
    v_dot2_f32_bf16 v41, v230, v22, v41
    v_dot2_f32_bf16 v41, v231, v23, v41
    s_waitcnt vmcnt(7)
    s_cbranch_vccnz L_s28
    s_waitcnt vmcnt(5)
    s_cbranch_scc1 L_s28
    s_waitcnt vmcnt(4)
L_s28:
    buffer_load_dwordx4 v[228:231], v1, s[32:35], s46 offen offset:1024 nt
    v_dot2_f32_bf16 v42, v232, v20, 0
    v_dot2_f32_bf16 v42, v233, v21, v42
    v_dot2_f32_bf16 v42, v234, v22, v42
    v_dot2_f32_bf16 v42, v235, v23, v42
    s_waitcnt vmcnt(7)
    s_cbranch_vccnz L_s29
    s_waitcnt vmcnt(5)
    s_cbranch_scc1 L_s29
    s_waitcnt vmcnt(4)
L_s29:
    buffer_load_dwordx4 v[232:235], v1, s[32:35], s46 offen offset:2048 nt
    v_dot2_f32_bf16 v43, v236, v20, 0
    v_dot2_f32_bf16 v43, v237, v21, v43
    v_dot2_f32_bf16 v43, v238, v22, v43
    v_dot2_f32_bf16 v43, v239, v23, v43
    s_waitcnt vmcnt(7)
    s_cbranch_vccnz L_s30
    s_waitcnt vmcnt(5)
    s_cbranch_scc1 L_s30
    s_waitcnt vmcnt(4)
L_s30:
    buffer_load_dwordx4 v[236:239], v1, s[32:35], s46 offen offset:3072 nt
    v_dot2_f32_bf16 v44, v240, v20, 0
    v_dot2_f32_bf16 v44, v241, v21, v44
    v_dot2_f32_bf16 v44, v242, v22, v44
    v_dot2_f32_bf16 v44, v243, v23, v44
    s_waitcnt vmcnt(7)
    s_cbranch_vccnz L_s31
    s_waitcnt vmcnt(5)
    s_cbranch_scc1 L_s31
    s_waitcnt vmcnt(4)
L_s31:
    buffer_load_dwordx4 v[240:243], v1, s[32:35], s47 offen offset:0 nt
    v_dot2_f32_bf16 v45, v244, v20, 0
    v_dot2_f32_bf16 v45, v245, v21, v45
    v_dot2_f32_bf16 v45, v246, v22, v45
    v_dot2_f32_bf16 v45, v247, v23, v45
    s_waitcnt vmcnt(7)
    s_cbranch_vccnz L_s32
    s_waitcnt vmcnt(5)
    s_cbranch_scc1 L_s32
    s_waitcnt vmcnt(4)
L_s32:
    buffer_load_dwordx4 v[244:247], v1, s[32:35], s47 offen offset:1024 nt
    v_dot2_f32_bf16 v46, v248, v20, 0
    v_dot2_f32_bf16 v46, v249, v21, v46
    v_dot2_f32_bf16 v46, v250, v22, v46
    v_dot2_f32_bf16 v46, v251, v23, v46
    s_waitcnt vmcnt(7)
    s_cbranch_vccnz L_s33
    s_waitcnt vmcnt(5)
    s_cbranch_scc1 L_s33
    s_waitcnt vmcnt(4)
L_s33:
    buffer_load_dwordx4 v[248:251], v1, s[32:35], s47 offen offset:2048 nt
    v_dot2_f32_bf16 v47, v252, v20, 0
    v_dot2_f32_bf16 v47, v253, v21, v47
    v_dot2_f32_bf16 v47, v254, v22, v47
    v_dot2_f32_bf16 v47, v255, v23, v47
    s_waitcnt vmcnt(7)
    s_cbranch_vccnz L_s34
    s_waitcnt vmcnt(5)
    s_cbranch_scc1 L_s34
    s_waitcnt vmcnt(4)
L_s34:
    s_memrealtime s[54:55]
    buffer_load_dwordx4 v[252:255], v1, s[32:35], s47 offen offset:3072 nt
    v_add_f32_dpp v32, v32, v32 row_ror:8 row_mask:0xf bank_mask:0x3
    v_add_f32_dpp v32, v40, v40 row_ror:8 row_mask:0xf bank_mask:0xc
    v_add_f32_dpp v33, v33, v33 row_ror:8 row_mask:0xf bank_mask:0x3
    v_add_f32_dpp v33, v41, v41 row_ror:8 row_mask:0xf bank_mask:0xc
    v_add_f32_dpp v34, v34, v34 row_ror:8 row_mask:0xf bank_mask:0x3
    v_add_f32_dpp v34, v42, v42 row_ror:8 row_mask:0xf bank_mask:0xc
    v_add_f32_dpp v35, v35, v35 row_ror:8 row_mask:0xf bank_mask:0x3
    v_add_f32_dpp v35, v43, v43 row_ror:8 row_mask:0xf bank_mask:0xc
    v_add_f32_dpp v36, v36, v36 row_ror:8 row_mask:0xf bank_mask:0x3
    v_add_f32_dpp v36, v44, v44 row_ror:8 row_mask:0xf bank_mask:0xc
    v_add_f32_dpp v37, v37, v37 row_ror:8 row_mask:0xf bank_mask:0x3
    v_add_f32_dpp v37, v45, v45 row_ror:8 row_mask:0xf bank_mask:0xc
    v_add_f32_dpp v38, v38, v38 row_ror:8 row_mask:0xf bank_mask:0x3
    v_add_f32_dpp v38, v46, v46 row_ror:8 row_mask:0xf bank_mask:0xc
    v_add_f32_dpp v39, v39, v39 row_ror:8 row_mask:0xf bank_mask:0x3
    v_add_f32_dpp v39, v47, v47 row_ror:8 row_mask:0xf bank_mask:0xc
    v_add_f32_dpp v32, v32, v32 row_shl:4 row_mask:0xf bank_mask:0x5
    v_add_f32_dpp v32, v36, v36 row_shr:4 row_mask:0xf bank_mask:0xa
    v_add_f32_dpp v33, v33, v33 row_shl:4 row_mask:0xf bank_mask:0x5
    v_add_f32_dpp v33, v37, v37 row_shr:4 row_mask:0xf bank_mask:0xa
    v_add_f32_dpp v34, v34, v34 row_shl:4 row_mask:0xf bank_mask:0x5
    v_add_f32_dpp v34, v38, v38 row_shr:4 row_mask:0xf bank_mask:0xa
    v_add_f32_dpp v35, v35, v35 row_shl:4 row_mask:0xf bank_mask:0x5
    v_add_f32_dpp v35, v39, v39 row_shr:4 row_mask:0xf bank_mask:0xa
    s_nop 0
    v_add_f32_dpp v32, v32, v32 quad_perm:[2,3,0,1] row_mask:0xf bank_mask:0xf
    v_add_f32_dpp v33, v33, v33 quad_perm:[2,3,0,1] row_mask:0xf bank_mask:0xf
    v_add_f32_dpp v34, v34, v34 quad_perm:[2,3,0,1] row_mask:0xf bank_mask:0xf
    v_add_f32_dpp v35, v35, v35 quad_perm:[2,3,0,1] row_mask:0xf bank_mask:0xf
    v_cndmask_b32 v32, v32, v34, s[40:41]
    v_cndmask_b32 v33, v33, v35, s[40:41]
    s_nop 0
    v_add_f32_dpp v32, v32, v32 quad_perm:[1,0,3,2] row_mask:0xf bank_mask:0xf
    v_add_f32_dpp v33, v33, v33 quad_perm:[1,0,3,2] row_mask:0xf bank_mask:0xf
    v_cndmask_b32 v32, v32, v33, s[42:43]
    v_cvt_pk_bf16_f32 v32, v32, v32
    v_and_b32 v32, 0xffff0000, v32
    v_mul_f32 v32, 0x3db504f3, v32
    v_cvt_pk_bf16_f32 v32, v32, v32
    v_and_b32 v32, 0xffff0000, v32
    v_max_f32 v24, v24, v32
    ds_write_b32 v28, v32 offset:5120
    v_add_u32 v28, 256, v28
    s_sub_u32 s70, s70, 1
    s_cmp_lg_u32 s70, 0
    s_cbranch_scc1 L_kloop
    s_waitcnt lgkmcnt(0)
    ds_read_b32 v32, v29 offset:5120
    ds_read_b32 v33, v29 offset:5376
    ds_read_b32 v34, v29 offset:5632
    ds_read_b32 v35, v29 offset:5888
    ds_read_b32 v36, v29 offset:6144
    ds_read_b32 v37, v29 offset:6400
    ds_read_b32 v38, v29 offset:6656
    ds_read_b32 v39, v29 offset:6912
    s_nop 1
    v_max_f32_dpp v24, v24, v24 row_ror:8 row_mask:0xf bank_mask:0xf
    s_nop 1
    v_max_f32_dpp v24, v24, v24 row_ror:4 row_mask:0xf bank_mask:0xf
    s_nop 1
    v_max_f32_dpp v24, v24, v24 row_ror:2 row_mask:0xf bank_mask:0xf
    s_nop 1
    v_max_f32_dpp v24, v24, v24 row_ror:1 row_mask:0xf bank_mask:0xf
    v_mov_b32 v30, v24
    s_nop 1
    v_permlane16_swap_b32 v24, v30
    s_nop 0
    v_max_f32 v24, v24, v30
    v_mov_b32 v30, v24
    s_nop 1
    v_permlane32_swap_b32 v24, v30
    s_nop 0
    v_max_f32 v24, v24, v30
    v_mul_f32 v28, s71, v24
    v_sub_f32 v28, 0, v28
    s_waitcnt lgkmcnt(0)
    v_fma_f32 v32, v32, s71, v28
    v_fma_f32 v33, v33, s71, v28
    v_fma_f32 v34, v34, s71, v28
    v_fma_f32 v35, v35, s71, v28
    v_fma_f32 v36, v36, s71, v28
    v_fma_f32 v37, v37, s71, v28
    v_fma_f32 v38, v38, s71, v28
    v_fma_f32 v39, v39, s71, v28
    v_exp_f32 v32, v32
    v_exp_f32 v33, v33
    v_exp_f32 v34, v34
    v_exp_f32 v35, v35
    v_exp_f32 v36, v36
    v_exp_f32 v37, v37
    v_exp_f32 v38, v38
    v_exp_f32 v39, v39
    v_add_f32 v25, v32, v33
    v_add_f32 v25, v25, v34
    v_add_f32 v25, v25, v35
    v_add_f32 v25, v25, v36
    v_add_f32 v25, v25, v37
    v_add_f32 v25, v25, v38
    v_add_f32 v25, v25, v39
    v_cvt_pk_bf16_f32 v32, v32, v32
    v_cvt_pk_bf16_f32 v33, v33, v33
    v_cvt_pk_bf16_f32 v34, v34, v34
    v_cvt_pk_bf16_f32 v35, v35, v35
    v_cvt_pk_bf16_f32 v36, v36, v36
    v_cvt_pk_bf16_f32 v37, v37, v37
    v_cvt_pk_bf16_f32 v38, v38, v38
    v_cvt_pk_bf16_f32 v39, v39, v39
    ds_write_b32 v29, v33 offset:5376
    ds_write_b32 v29, v34 offset:5632
    ds_write_b32 v29, v35 offset:5888
    ds_write_b32 v29, v36 offset:6144
    ds_write_b32 v29, v37 offset:6400
    ds_write_b32 v29, v38 offset:6656
    ds_write_b32 v29, v39 offset:6912
    v_mov_b32 v27, v32
    s_nop 1
    v_add_f32_dpp v25, v25, v25 row_ror:8 row_mask:0xf bank_mask:0xf
    s_nop 1
    v_add_f32_dpp v25, v25, v25 row_ror:4 row_mask:0xf bank_mask:0xf
    s_nop 1
    v_add_f32_dpp v25, v25, v25 row_ror:2 row_mask:0xf bank_mask:0xf
    s_nop 1
    v_add_f32_dpp v25, v25, v25 row_ror:1 row_mask:0xf bank_mask:0xf
    v_mov_b32 v30, v25
    s_nop 1
    v_permlane16_swap_b32 v25, v30
    s_nop 0
    v_add_f32 v25, v25, v30
    v_mov_b32 v30, v25
    s_nop 1
    v_permlane32_swap_b32 v25, v30
    s_nop 0
    v_add_f32 v25, v25, v30
    s_mov_b64 exec, 1
    s_lshl_b32 s65, s64, 3
    v_mov_b32 v2, s65
    ds_write_b64 v2, v[24:25] offset:4096
    v_mov_b32 v30, 0
    v_mov_b32 v31, 1
    s_waitcnt lgkmcnt(0)
    ds_add_u32 v30, v31 offset:4164
    s_mov_b64 exec, -1
L_vloop:
    s_add_u32 s44, s44, 0x40000
    s_add_u32 s45, s45, 0x40000
    s_add_u32 s46, s46, 0x40000
    s_add_u32 s47, s47, 0x40000
    s_cmp_lt_u32 s44, 0x200000
    s_cselect_b64 vcc, 0, -1
    s_waitcnt lgkmcnt(0)
    v_mov_b32 v26, v27
    v_add_u32 v29, 256, v29
    s_waitcnt lgkmcnt(0)
    s_add_u32 s68, s68, 108
    s_sub_u32 s53, s54, s68
    s_cmp_gt_i32 s53, 50
    s_cselect_b32 s52, 2, 0
    s_cmp_gt_i32 s53, -5
    s_addc_u32 s52, s52, 0
    ds_read_b32 v27, v29 offset:5120
    v_and_b32_dpp v8, v26, v4 row_newbcast:0 row_mask:0xf bank_mask:0xf
    v_and_b32_dpp v9, v26, v5 row_newbcast:0 row_mask:0xf bank_mask:0xf
    v_and_b32_dpp v10, v26, v6 row_newbcast:0 row_mask:0xf bank_mask:0xf
    v_and_b32_dpp v11, v26, v7 row_newbcast:0 row_mask:0xf bank_mask:0xf
    v_and_b32_dpp v12, v26, v4 row_newbcast:1 row_mask:0xf bank_mask:0xf
    v_and_b32_dpp v13, v26, v5 row_newbcast:1 row_mask:0xf bank_mask:0xf
    v_and_b32_dpp v14, v26, v6 row_newbcast:1 row_mask:0xf bank_mask:0xf
    v_and_b32_dpp v15, v26, v7 row_newbcast:1 row_mask:0xf bank_mask:0xf
    s_cmp_lg_u32 s44, 0x200000
    s_cbranch_scc1 L_s35
    s_mov_b64 exec, 1
    ds_add_u32 v30, v31 offset:4172
    s_mov_b64 exec, -1
L_s35:
    s_waitcnt vmcnt(31)
    v_mfma_f32_16x16x32_bf16 v[16:19], v[8:11], v[128:131], v[16:19]
    s_cbranch_vccnz L_s36
    s_bitcmp1_b32 s52, 1
    s_waitcnt vmcnt(7)
    s_cbranch_scc1 L_s36
    s_bitcmp1_b32 s52, 0
    s_waitcnt vmcnt(5)
    s_cbranch_scc1 L_s36
    s_waitcnt vmcnt(4)
L_s36:
    buffer_load_dwordx4 v[128:131], v1, s[32:35], s44 offen offset:0 nt
    v_and_b32_dpp v8, v26, v4 row_newbcast:2 row_mask:0xf bank_mask:0xf
    v_and_b32_dpp v9, v26, v5 row_newbcast:2 row_mask:0xf bank_mask:0xf
    v_and_b32_dpp v10, v26, v6 row_newbcast:2 row_mask:0xf bank_mask:0xf
    v_and_b32_dpp v11, v26, v7 row_newbcast:2 row_mask:0xf bank_mask:0xf
    s_waitcnt vmcnt(31)
    v_mfma_f32_16x16x32_bf16 v[16:19], v[12:15], v[132:135], v[16:19]
    s_cbranch_vccnz L_s37
    s_bitcmp1_b32 s52, 1
    s_waitcnt vmcnt(7)
    s_cbranch_scc1 L_s37
    s_bitcmp1_b32 s52, 0
    s_waitcnt vmcnt(5)
    s_cbranch_scc1 L_s37
    s_waitcnt vmcnt(4)
L_s37:
    buffer_load_dwordx4 v[132:135], v1, s[32:35], s44 offen offset:1024 nt
    v_and_b32_dpp v12, v26, v4 row_newbcast:3 row_mask:0xf bank_mask:0xf
    v_and_b32_dpp v13, v26, v5 row_newbcast:3 row_mask:0xf bank_mask:0xf
    v_and_b32_dpp v14, v26, v6 row_newbcast:3 row_mask:0xf bank_mask:0xf
    v_and_b32_dpp v15, v26, v7 row_newbcast:3 row_mask:0xf bank_mask:0xf
    s_waitcnt vmcnt(31)
    v_mfma_f32_16x16x32_bf16 v[16:19], v[8:11], v[136:139], v[16:19]
    s_cbranch_vccnz L_s38
    s_bitcmp1_b32 s52, 1
    s_waitcnt vmcnt(7)
    s_cbranch_scc1 L_s38
    s_bitcmp1_b32 s52, 0
    s_waitcnt vmcnt(5)
    s_cbranch_scc1 L_s38
    s_waitcnt vmcnt(4)
L_s38:
    buffer_load_dwordx4 v[136:139], v1, s[32:35], s44 offen offset:2048 nt
    v_and_b32_dpp v8, v26, v4 row_newbcast:4 row_mask:0xf bank_mask:0xf
    v_and_b32_dpp v9, v26, v5 row_newbcast:4 row_mask:0xf bank_mask:0xf
    v_and_b32_dpp v10, v26, v6 row_newbcast:4 row_mask:0xf bank_mask:0xf
    v_and_b32_dpp v11, v26, v7 row_newbcast:4 row_mask:0xf bank_mask:0xf
    s_waitcnt vmcnt(31)
    v_mfma_f32_16x16x32_bf16 v[16:19], v[12:15], v[140:143], v[16:19]
    s_cbranch_vccnz L_s39
    s_bitcmp1_b32 s52, 1
    s_waitcnt vmcnt(7)
    s_cbranch_scc1 L_s39
    s_bitcmp1_b32 s52, 0
    s_waitcnt vmcnt(5)
    s_cbranch_scc1 L_s39
    s_waitcnt vmcnt(4)
L_s39:
    buffer_load_dwordx4 v[140:143], v1, s[32:35], s44 offen offset:3072 nt
    v_and_b32_dpp v12, v26, v4 row_newbcast:5 row_mask:0xf bank_mask:0xf
    v_and_b32_dpp v13, v26, v5 row_newbcast:5 row_mask:0xf bank_mask:0xf
    v_and_b32_dpp v14, v26, v6 row_newbcast:5 row_mask:0xf bank_mask:0xf
    v_and_b32_dpp v15, v26, v7 row_newbcast:5 row_mask:0xf bank_mask:0xf
    s_waitcnt vmcnt(31)
    v_mfma_f32_16x16x32_bf16 v[16:19], v[8:11], v[144:147], v[16:19]
    s_cbranch_vccnz L_s40
    s_bitcmp1_b32 s52, 1
    s_waitcnt vmcnt(7)
    s_cbranch_scc1 L_s40
    s_bitcmp1_b32 s52, 0
    s_waitcnt vmcnt(5)
    s_cbranch_scc1 L_s40
    s_waitcnt vmcnt(4)
L_s40:
    buffer_load_dwordx4 v[144:147], v1, s[32:35], s45 offen offset:0 nt
    v_and_b32_dpp v8, v26, v4 row_newbcast:6 row_mask:0xf bank_mask:0xf
    v_and_b32_dpp v9, v26, v5 row_newbcast:6 row_mask:0xf bank_mask:0xf
    v_and_b32_dpp v10, v26, v6 row_newbcast:6 row_mask:0xf bank_mask:0xf
    v_and_b32_dpp v11, v26, v7 row_newbcast:6 row_mask:0xf bank_mask:0xf
    s_waitcnt vmcnt(31)
    v_mfma_f32_16x16x32_bf16 v[16:19], v[12:15], v[148:151], v[16:19]
    s_cbranch_vccnz L_s41
    s_bitcmp1_b32 s52, 1
    s_waitcnt vmcnt(7)
    s_cbranch_scc1 L_s41
    s_bitcmp1_b32 s52, 0
    s_waitcnt vmcnt(5)
    s_cbranch_scc1 L_s41
    s_waitcnt vmcnt(4)
L_s41:
    buffer_load_dwordx4 v[148:151], v1, s[32:35], s45 offen offset:1024 nt
    v_and_b32_dpp v12, v26, v4 row_newbcast:7 row_mask:0xf bank_mask:0xf
    v_and_b32_dpp v13, v26, v5 row_newbcast:7 row_mask:0xf bank_mask:0xf
    v_and_b32_dpp v14, v26, v6 row_newbcast:7 row_mask:0xf bank_mask:0xf
    v_and_b32_dpp v15, v26, v7 row_newbcast:7 row_mask:0xf bank_mask:0xf
    s_waitcnt vmcnt(31)
    v_mfma_f32_16x16x32_bf16 v[16:19], v[8:11], v[152:155], v[16:19]
    s_cbranch_vccnz L_s42
    s_bitcmp1_b32 s52, 1
    s_waitcnt vmcnt(7)
    s_cbranch_scc1 L_s42
    s_bitcmp1_b32 s52, 0
    s_waitcnt vmcnt(5)
    s_cbranch_scc1 L_s42
    s_waitcnt vmcnt(4)
L_s42:
    buffer_load_dwordx4 v[152:155], v1, s[32:35], s45 offen offset:2048 nt
    v_and_b32_dpp v8, v26, v4 row_newbcast:8 row_mask:0xf bank_mask:0xf
    v_and_b32_dpp v9, v26, v5 row_newbcast:8 row_mask:0xf bank_mask:0xf
    v_and_b32_dpp v10, v26, v6 row_newbcast:8 row_mask:0xf bank_mask:0xf
    v_and_b32_dpp v11, v26, v7 row_newbcast:8 row_mask:0xf bank_mask:0xf
    s_waitcnt vmcnt(31)
    v_mfma_f32_16x16x32_bf16 v[16:19], v[12:15], v[156:159], v[16:19]
    s_cbranch_vccnz L_s43
    s_bitcmp1_b32 s52, 1
    s_waitcnt vmcnt(7)
    s_cbranch_scc1 L_s43
    s_bitcmp1_b32 s52, 0
    s_waitcnt vmcnt(5)
    s_cbranch_scc1 L_s43
    s_waitcnt vmcnt(4)
L_s43:
    s_memrealtime s[54:55]
    buffer_load_dwordx4 v[156:159], v1, s[32:35], s45 offen offset:3072 nt
    v_and_b32_dpp v12, v26, v4 row_newbcast:9 row_mask:0xf bank_mask:0xf
    v_and_b32_dpp v13, v26, v5 row_newbcast:9 row_mask:0xf bank_mask:0xf
    v_and_b32_dpp v14, v26, v6 row_newbcast:9 row_mask:0xf bank_mask:0xf
    v_and_b32_dpp v15, v26, v7 row_newbcast:9 row_mask:0xf bank_mask:0xf
    s_waitcnt lgkmcnt(0)
    s_add_u32 s68, s68, 108
    s_sub_u32 s53, s54, s68
    s_cmp_gt_i32 s53, 50
    s_cselect_b32 s52, 2, 0
    s_cmp_gt_i32 s53, -5
    s_addc_u32 s52, s52, 0
    s_waitcnt vmcnt(31)
    v_mfma_f32_16x16x32_bf16 v[16:19], v[8:11], v[160:163], v[16:19]
    s_cbranch_vccnz L_s44
    s_bitcmp1_b32 s52, 1
    s_waitcnt vmcnt(7)
    s_cbranch_scc1 L_s44
    s_bitcmp1_b32 s52, 0
    s_waitcnt vmcnt(5)
    s_cbranch_scc1 L_s44
    s_waitcnt vmcnt(4)
L_s44:
    buffer_load_dwordx4 v[160:163], v1, s[32:35], s46 offen offset:0 nt
    v_and_b32_dpp v8, v26, v4 row_newbcast:10 row_mask:0xf bank_mask:0xf
    v_and_b32_dpp v9, v26, v5 row_newbcast:10 row_mask:0xf bank_mask:0xf
    v_and_b32_dpp v10, v26, v6 row_newbcast:10 row_mask:0xf bank_mask:0xf
    v_and_b32_dpp v11, v26, v7 row_newbcast:10 row_mask:0xf bank_mask:0xf
    s_waitcnt vmcnt(31)
    v_mfma_f32_16x16x32_bf16 v[16:19], v[12:15], v[164:167], v[16:19]
    s_cbranch_vccnz L_s45
    s_bitcmp1_b32 s52, 1
    s_waitcnt vmcnt(7)
    s_cbranch_scc1 L_s45
    s_bitcmp1_b32 s52, 0
    s_waitcnt vmcnt(5)
    s_cbranch_scc1 L_s45
    s_waitcnt vmcnt(4)
L_s45:
    buffer_load_dwordx4 v[164:167], v1, s[32:35], s46 offen offset:1024 nt
    v_and_b32_dpp v12, v26, v4 row_newbcast:11 row_mask:0xf bank_mask:0xf
    v_and_b32_dpp v13, v26, v5 row_newbcast:11 row_mask:0xf bank_mask:0xf
    v_and_b32_dpp v14, v26, v6 row_newbcast:11 row_mask:0xf bank_mask:0xf
    v_and_b32_dpp v15, v26, v7 row_newbcast:11 row_mask:0xf bank_mask:0xf
    s_waitcnt vmcnt(31)
    v_mfma_f32_16x16x32_bf16 v[16:19], v[8:11], v[168:171], v[16:19]
    s_cbranch_vccnz L_s46
    s_bitcmp1_b32 s52, 1
    s_waitcnt vmcnt(7)
    s_cbranch_scc1 L_s46
    s_bitcmp1_b32 s52, 0
    s_waitcnt vmcnt(5)
    s_cbranch_scc1 L_s46
    s_waitcnt vmcnt(4)
L_s46:
    buffer_load_dwordx4 v[168:171], v1, s[32:35], s46 offen offset:2048 nt
    v_and_b32_dpp v8, v26, v4 row_newbcast:12 row_mask:0xf bank_mask:0xf
    v_and_b32_dpp v9, v26, v5 row_newbcast:12 row_mask:0xf bank_mask:0xf
    v_and_b32_dpp v10, v26, v6 row_newbcast:12 row_mask:0xf bank_mask:0xf
    v_and_b32_dpp v11, v26, v7 row_newbcast:12 row_mask:0xf bank_mask:0xf
    s_waitcnt vmcnt(31)
    v_mfma_f32_16x16x32_bf16 v[16:19], v[12:15], v[172:175], v[16:19]
    s_cbranch_vccnz L_s47
    s_bitcmp1_b32 s52, 1
    s_waitcnt vmcnt(7)
    s_cbranch_scc1 L_s47
    s_bitcmp1_b32 s52, 0
    s_waitcnt vmcnt(5)
    s_cbranch_scc1 L_s47
    s_waitcnt vmcnt(4)
L_s47:
    buffer_load_dwordx4 v[172:175], v1, s[32:35], s46 offen offset:3072 nt
    v_and_b32_dpp v12, v26, v4 row_newbcast:13 row_mask:0xf bank_mask:0xf
    v_and_b32_dpp v13, v26, v5 row_newbcast:13 row_mask:0xf bank_mask:0xf
    v_and_b32_dpp v14, v26, v6 row_newbcast:13 row_mask:0xf bank_mask:0xf
    v_and_b32_dpp v15, v26, v7 row_newbcast:13 row_mask:0xf bank_mask:0xf
    s_waitcnt vmcnt(31)
    v_mfma_f32_16x16x32_bf16 v[16:19], v[8:11], v[176:179], v[16:19]
    s_cbranch_vccnz L_s48
    s_bitcmp1_b32 s52, 1
    s_waitcnt vmcnt(7)
    s_cbranch_scc1 L_s48
    s_bitcmp1_b32 s52, 0
    s_waitcnt vmcnt(5)
    s_cbranch_scc1 L_s48
    s_waitcnt vmcnt(4)
L_s48:
    buffer_load_dwordx4 v[176:179], v1, s[32:35], s47 offen offset:0 nt
    v_and_b32_dpp v8, v26, v4 row_newbcast:14 row_mask:0xf bank_mask:0xf
    v_and_b32_dpp v9, v26, v5 row_newbcast:14 row_mask:0xf bank_mask:0xf
    v_and_b32_dpp v10, v26, v6 row_newbcast:14 row_mask:0xf bank_mask:0xf
    v_and_b32_dpp v11, v26, v7 row_newbcast:14 row_mask:0xf bank_mask:0xf
    s_waitcnt vmcnt(31)
    v_mfma_f32_16x16x32_bf16 v[16:19], v[12:15], v[180:183], v[16:19]
    s_cbranch_vccnz L_s49
    s_bitcmp1_b32 s52, 1
    s_waitcnt vmcnt(7)
    s_cbranch_scc1 L_s49
    s_bitcmp1_b32 s52, 0
    s_waitcnt vmcnt(5)
    s_cbranch_scc1 L_s49
    s_waitcnt vmcnt(4)
L_s49:
    buffer_load_dwordx4 v[180:183], v1, s[32:35], s47 offen offset:1024 nt
    v_and_b32_dpp v12, v26, v4 row_newbcast:15 row_mask:0xf bank_mask:0xf
    v_and_b32_dpp v13, v26, v5 row_newbcast:15 row_mask:0xf bank_mask:0xf
    v_and_b32_dpp v14, v26, v6 row_newbcast:15 row_mask:0xf bank_mask:0xf
    v_and_b32_dpp v15, v26, v7 row_newbcast:15 row_mask:0xf bank_mask:0xf
    s_waitcnt vmcnt(31)
    v_mfma_f32_16x16x32_bf16 v[16:19], v[8:11], v[184:187], v[16:19]
    s_cbranch_vccnz L_s50
    s_bitcmp1_b32 s52, 1
    s_waitcnt vmcnt(7)
    s_cbranch_scc1 L_s50
    s_bitcmp1_b32 s52, 0
    s_waitcnt vmcnt(5)
    s_cbranch_scc1 L_s50
    s_waitcnt vmcnt(4)
L_s50:
    buffer_load_dwordx4 v[184:187], v1, s[32:35], s47 offen offset:2048 nt
    s_waitcnt vmcnt(31)
    v_mfma_f32_16x16x32_bf16 v[16:19], v[12:15], v[188:191], v[16:19]
    s_cbranch_vccnz L_s51
    s_bitcmp1_b32 s52, 1
    s_waitcnt vmcnt(7)
    s_cbranch_scc1 L_s51
    s_bitcmp1_b32 s52, 0
    s_waitcnt vmcnt(5)
    s_cbranch_scc1 L_s51
    s_waitcnt vmcnt(4)
L_s51:
    s_memrealtime s[54:55]
    buffer_load_dwordx4 v[188:191], v1, s[32:35], s47 offen offset:3072 nt
    s_add_u32 s44, s44, 0x40000
    s_add_u32 s45, s45, 0x40000
    s_add_u32 s46, s46, 0x40000
    s_add_u32 s47, s47, 0x40000
    s_cmp_lt_u32 s44, 0x200000
    s_cselect_b64 vcc, 0, -1
    s_waitcnt lgkmcnt(0)
    v_mov_b32 v26, v27
    v_add_u32 v29, 256, v29
    s_waitcnt lgkmcnt(0)
    s_add_u32 s68, s68, 108
    s_sub_u32 s53, s54, s68
    s_cmp_gt_i32 s53, 50
    s_cselect_b32 s52, 2, 0
    s_cmp_gt_i32 s53, -5
    s_addc_u32 s52, s52, 0
    ds_read_b32 v27, v29 offset:5120
    v_and_b32_dpp v8, v26, v4 row_newbcast:0 row_mask:0xf bank_mask:0xf
    v_and_b32_dpp v9, v26, v5 row_newbcast:0 row_mask:0xf bank_mask:0xf
    v_and_b32_dpp v10, v26, v6 row_newbcast:0 row_mask:0xf bank_mask:0xf
    v_and_b32_dpp v11, v26, v7 row_newbcast:0 row_mask:0xf bank_mask:0xf
    v_and_b32_dpp v12, v26, v4 row_newbcast:1 row_mask:0xf bank_mask:0xf
    v_and_b32_dpp v13, v26, v5 row_newbcast:1 row_mask:0xf bank_mask:0xf
    v_and_b32_dpp v14, v26, v6 row_newbcast:1 row_mask:0xf bank_mask:0xf
    v_and_b32_dpp v15, v26, v7 row_newbcast:1 row_mask:0xf bank_mask:0xf
    s_waitcnt vmcnt(31)
    v_mfma_f32_16x16x32_bf16 v[16:19], v[8:11], v[192:195], v[16:19]
    s_cbranch_vccnz L_s52
    s_bitcmp1_b32 s52, 1
    s_waitcnt vmcnt(7)
    s_cbranch_scc1 L_s52
    s_bitcmp1_b32 s52, 0
    s_waitcnt vmcnt(5)
    s_cbranch_scc1 L_s52
    s_waitcnt vmcnt(4)
L_s52:
    buffer_load_dwordx4 v[192:195], v1, s[32:35], s44 offen offset:0 nt
    v_and_b32_dpp v8, v26, v4 row_newbcast:2 row_mask:0xf bank_mask:0xf
    v_and_b32_dpp v9, v26, v5 row_newbcast:2 row_mask:0xf bank_mask:0xf
    v_and_b32_dpp v10, v26, v6 row_newbcast:2 row_mask:0xf bank_mask:0xf
    v_and_b32_dpp v11, v26, v7 row_newbcast:2 row_mask:0xf bank_mask:0xf
    s_waitcnt vmcnt(31)
    v_mfma_f32_16x16x32_bf16 v[16:19], v[12:15], v[196:199], v[16:19]
    s_cbranch_vccnz L_s53
    s_bitcmp1_b32 s52, 1
    s_waitcnt vmcnt(7)
    s_cbranch_scc1 L_s53
    s_bitcmp1_b32 s52, 0
    s_waitcnt vmcnt(5)
    s_cbranch_scc1 L_s53
    s_waitcnt vmcnt(4)
L_s53:
    buffer_load_dwordx4 v[196:199], v1, s[32:35], s44 offen offset:1024 nt
    v_and_b32_dpp v12, v26, v4 row_newbcast:3 row_mask:0xf bank_mask:0xf
    v_and_b32_dpp v13, v26, v5 row_newbcast:3 row_mask:0xf bank_mask:0xf
    v_and_b32_dpp v14, v26, v6 row_newbcast:3 row_mask:0xf bank_mask:0xf
    v_and_b32_dpp v15, v26, v7 row_newbcast:3 row_mask:0xf bank_mask:0xf
    s_waitcnt vmcnt(31)
    v_mfma_f32_16x16x32_bf16 v[16:19], v[8:11], v[200:203], v[16:19]
    s_cbranch_vccnz L_s54
    s_bitcmp1_b32 s52, 1
    s_waitcnt vmcnt(7)
    s_cbranch_scc1 L_s54
    s_bitcmp1_b32 s52, 0
    s_waitcnt vmcnt(5)
    s_cbranch_scc1 L_s54
    s_waitcnt vmcnt(4)
L_s54:
    buffer_load_dwordx4 v[200:203], v1, s[32:35], s44 offen offset:2048 nt
    v_and_b32_dpp v8, v26, v4 row_newbcast:4 row_mask:0xf bank_mask:0xf
    v_and_b32_dpp v9, v26, v5 row_newbcast:4 row_mask:0xf bank_mask:0xf
    v_and_b32_dpp v10, v26, v6 row_newbcast:4 row_mask:0xf bank_mask:0xf
    v_and_b32_dpp v11, v26, v7 row_newbcast:4 row_mask:0xf bank_mask:0xf
    s_waitcnt vmcnt(31)
    v_mfma_f32_16x16x32_bf16 v[16:19], v[12:15], v[204:207], v[16:19]
    s_cbranch_vccnz L_s55
    s_bitcmp1_b32 s52, 1
    s_waitcnt vmcnt(7)
    s_cbranch_scc1 L_s55
    s_bitcmp1_b32 s52, 0
    s_waitcnt vmcnt(5)
    s_cbranch_scc1 L_s55
    s_waitcnt vmcnt(4)
L_s55:
    buffer_load_dwordx4 v[204:207], v1, s[32:35], s44 offen offset:3072 nt
    v_and_b32_dpp v12, v26, v4 row_newbcast:5 row_mask:0xf bank_mask:0xf
    v_and_b32_dpp v13, v26, v5 row_newbcast:5 row_mask:0xf bank_mask:0xf
    v_and_b32_dpp v14, v26, v6 row_newbcast:5 row_mask:0xf bank_mask:0xf
    v_and_b32_dpp v15, v26, v7 row_newbcast:5 row_mask:0xf bank_mask:0xf
    s_waitcnt vmcnt(31)
    v_mfma_f32_16x16x32_bf16 v[16:19], v[8:11], v[208:211], v[16:19]
    s_cbranch_vccnz L_s56
    s_bitcmp1_b32 s52, 1
    s_waitcnt vmcnt(7)
    s_cbranch_scc1 L_s56
    s_bitcmp1_b32 s52, 0
    s_waitcnt vmcnt(5)
    s_cbranch_scc1 L_s56
    s_waitcnt vmcnt(4)
L_s56:
    buffer_load_dwordx4 v[208:211], v1, s[32:35], s45 offen offset:0 nt
    v_and_b32_dpp v8, v26, v4 row_newbcast:6 row_mask:0xf bank_mask:0xf
    v_and_b32_dpp v9, v26, v5 row_newbcast:6 row_mask:0xf bank_mask:0xf
    v_and_b32_dpp v10, v26, v6 row_newbcast:6 row_mask:0xf bank_mask:0xf
    v_and_b32_dpp v11, v26, v7 row_newbcast:6 row_mask:0xf bank_mask:0xf
    s_waitcnt vmcnt(31)
    v_mfma_f32_16x16x32_bf16 v[16:19], v[12:15], v[212:215], v[16:19]
    s_cbranch_vccnz L_s57
    s_bitcmp1_b32 s52, 1
    s_waitcnt vmcnt(7)
    s_cbranch_scc1 L_s57
    s_bitcmp1_b32 s52, 0
    s_waitcnt vmcnt(5)
    s_cbranch_scc1 L_s57
    s_waitcnt vmcnt(4)
L_s57:
    buffer_load_dwordx4 v[212:215], v1, s[32:35], s45 offen offset:1024 nt
    v_and_b32_dpp v12, v26, v4 row_newbcast:7 row_mask:0xf bank_mask:0xf
    v_and_b32_dpp v13, v26, v5 row_newbcast:7 row_mask:0xf bank_mask:0xf
    v_and_b32_dpp v14, v26, v6 row_newbcast:7 row_mask:0xf bank_mask:0xf
    v_and_b32_dpp v15, v26, v7 row_newbcast:7 row_mask:0xf bank_mask:0xf
    s_waitcnt vmcnt(31)
    v_mfma_f32_16x16x32_bf16 v[16:19], v[8:11], v[216:219], v[16:19]
    s_cbranch_vccnz L_s58
    s_bitcmp1_b32 s52, 1
    s_waitcnt vmcnt(7)
    s_cbranch_scc1 L_s58
    s_bitcmp1_b32 s52, 0
    s_waitcnt vmcnt(5)
    s_cbranch_scc1 L_s58
    s_waitcnt vmcnt(4)
L_s58:
    buffer_load_dwordx4 v[216:219], v1, s[32:35], s45 offen offset:2048 nt
    v_and_b32_dpp v8, v26, v4 row_newbcast:8 row_mask:0xf bank_mask:0xf
    v_and_b32_dpp v9, v26, v5 row_newbcast:8 row_mask:0xf bank_mask:0xf
    v_and_b32_dpp v10, v26, v6 row_newbcast:8 row_mask:0xf bank_mask:0xf
    v_and_b32_dpp v11, v26, v7 row_newbcast:8 row_mask:0xf bank_mask:0xf
    s_waitcnt vmcnt(31)
    v_mfma_f32_16x16x32_bf16 v[16:19], v[12:15], v[220:223], v[16:19]
    s_cbranch_vccnz L_s59
    s_bitcmp1_b32 s52, 1
    s_waitcnt vmcnt(7)
    s_cbranch_scc1 L_s59
    s_bitcmp1_b32 s52, 0
    s_waitcnt vmcnt(5)
    s_cbranch_scc1 L_s59
    s_waitcnt vmcnt(4)
L_s59:
    s_memrealtime s[54:55]
    buffer_load_dwordx4 v[220:223], v1, s[32:35], s45 offen offset:3072 nt
    v_and_b32_dpp v12, v26, v4 row_newbcast:9 row_mask:0xf bank_mask:0xf
    v_and_b32_dpp v13, v26, v5 row_newbcast:9 row_mask:0xf bank_mask:0xf
    v_and_b32_dpp v14, v26, v6 row_newbcast:9 row_mask:0xf bank_mask:0xf
    v_and_b32_dpp v15, v26, v7 row_newbcast:9 row_mask:0xf bank_mask:0xf
    s_waitcnt lgkmcnt(0)
    s_add_u32 s68, s68, 108
    s_sub_u32 s53, s54, s68
    s_cmp_gt_i32 s53, 50
    s_cselect_b32 s52, 2, 0
    s_cmp_gt_i32 s53, -5
    s_addc_u32 s52, s52, 0
    s_waitcnt vmcnt(31)
    v_mfma_f32_16x16x32_bf16 v[16:19], v[8:11], v[224:227], v[16:19]
    s_cbranch_vccnz L_s60
    s_bitcmp1_b32 s52, 1
    s_waitcnt vmcnt(7)
    s_cbranch_scc1 L_s60
    s_bitcmp1_b32 s52, 0
    s_waitcnt vmcnt(5)
    s_cbranch_scc1 L_s60
    s_waitcnt vmcnt(4)
L_s60:
    buffer_load_dwordx4 v[224:227], v1, s[32:35], s46 offen offset:0 nt
    v_and_b32_dpp v8, v26, v4 row_newbcast:10 row_mask:0xf bank_mask:0xf
    v_and_b32_dpp v9, v26, v5 row_newbcast:10 row_mask:0xf bank_mask:0xf
    v_and_b32_dpp v10, v26, v6 row_newbcast:10 row_mask:0xf bank_mask:0xf
    v_and_b32_dpp v11, v26, v7 row_newbcast:10 row_mask:0xf bank_mask:0xf
    s_waitcnt vmcnt(31)
    v_mfma_f32_16x16x32_bf16 v[16:19], v[12:15], v[228:231], v[16:19]
    s_cbranch_vccnz L_s61
    s_bitcmp1_b32 s52, 1
    s_waitcnt vmcnt(7)
    s_cbranch_scc1 L_s61
    s_bitcmp1_b32 s52, 0
    s_waitcnt vmcnt(5)
    s_cbranch_scc1 L_s61
    s_waitcnt vmcnt(4)
L_s61:
    buffer_load_dwordx4 v[228:231], v1, s[32:35], s46 offen offset:1024 nt
    v_and_b32_dpp v12, v26, v4 row_newbcast:11 row_mask:0xf bank_mask:0xf
    v_and_b32_dpp v13, v26, v5 row_newbcast:11 row_mask:0xf bank_mask:0xf
    v_and_b32_dpp v14, v26, v6 row_newbcast:11 row_mask:0xf bank_mask:0xf
    v_and_b32_dpp v15, v26, v7 row_newbcast:11 row_mask:0xf bank_mask:0xf
    s_waitcnt vmcnt(31)
    v_mfma_f32_16x16x32_bf16 v[16:19], v[8:11], v[232:235], v[16:19]
    s_cbranch_vccnz L_s62
    s_bitcmp1_b32 s52, 1
    s_waitcnt vmcnt(7)
    s_cbranch_scc1 L_s62
    s_bitcmp1_b32 s52, 0
    s_waitcnt vmcnt(5)
    s_cbranch_scc1 L_s62
    s_waitcnt vmcnt(4)
L_s62:
    buffer_load_dwordx4 v[232:235], v1, s[32:35], s46 offen offset:2048 nt
    v_and_b32_dpp v8, v26, v4 row_newbcast:12 row_mask:0xf bank_mask:0xf
    v_and_b32_dpp v9, v26, v5 row_newbcast:12 row_mask:0xf bank_mask:0xf
    v_and_b32_dpp v10, v26, v6 row_newbcast:12 row_mask:0xf bank_mask:0xf
    v_and_b32_dpp v11, v26, v7 row_newbcast:12 row_mask:0xf bank_mask:0xf
    s_waitcnt vmcnt(31)
    v_mfma_f32_16x16x32_bf16 v[16:19], v[12:15], v[236:239], v[16:19]
    s_cbranch_vccnz L_s63
    s_bitcmp1_b32 s52, 1
    s_waitcnt vmcnt(7)
    s_cbranch_scc1 L_s63
    s_bitcmp1_b32 s52, 0
    s_waitcnt vmcnt(5)
    s_cbranch_scc1 L_s63
    s_waitcnt vmcnt(4)
L_s63:
    buffer_load_dwordx4 v[236:239], v1, s[32:35], s46 offen offset:3072 nt
    v_and_b32_dpp v12, v26, v4 row_newbcast:13 row_mask:0xf bank_mask:0xf
    v_and_b32_dpp v13, v26, v5 row_newbcast:13 row_mask:0xf bank_mask:0xf
    v_and_b32_dpp v14, v26, v6 row_newbcast:13 row_mask:0xf bank_mask:0xf
    v_and_b32_dpp v15, v26, v7 row_newbcast:13 row_mask:0xf bank_mask:0xf
    s_waitcnt vmcnt(31)
    v_mfma_f32_16x16x32_bf16 v[16:19], v[8:11], v[240:243], v[16:19]
    s_cbranch_vccnz L_s64
    s_bitcmp1_b32 s52, 1
    s_waitcnt vmcnt(7)
    s_cbranch_scc1 L_s64
    s_bitcmp1_b32 s52, 0
    s_waitcnt vmcnt(5)
    s_cbranch_scc1 L_s64
    s_waitcnt vmcnt(4)
L_s64:
    buffer_load_dwordx4 v[240:243], v1, s[32:35], s47 offen offset:0 nt
    v_and_b32_dpp v8, v26, v4 row_newbcast:14 row_mask:0xf bank_mask:0xf
    v_and_b32_dpp v9, v26, v5 row_newbcast:14 row_mask:0xf bank_mask:0xf
    v_and_b32_dpp v10, v26, v6 row_newbcast:14 row_mask:0xf bank_mask:0xf
    v_and_b32_dpp v11, v26, v7 row_newbcast:14 row_mask:0xf bank_mask:0xf
    s_waitcnt vmcnt(31)
    v_mfma_f32_16x16x32_bf16 v[16:19], v[12:15], v[244:247], v[16:19]
    s_cbranch_vccnz L_s65
    s_bitcmp1_b32 s52, 1
    s_waitcnt vmcnt(7)
    s_cbranch_scc1 L_s65
    s_bitcmp1_b32 s52, 0
    s_waitcnt vmcnt(5)
    s_cbranch_scc1 L_s65
    s_waitcnt vmcnt(4)
L_s65:
    buffer_load_dwordx4 v[244:247], v1, s[32:35], s47 offen offset:1024 nt
    v_and_b32_dpp v12, v26, v4 row_newbcast:15 row_mask:0xf bank_mask:0xf
    v_and_b32_dpp v13, v26, v5 row_newbcast:15 row_mask:0xf bank_mask:0xf
    v_and_b32_dpp v14, v26, v6 row_newbcast:15 row_mask:0xf bank_mask:0xf
    v_and_b32_dpp v15, v26, v7 row_newbcast:15 row_mask:0xf bank_mask:0xf
    s_waitcnt vmcnt(31)
    v_mfma_f32_16x16x32_bf16 v[16:19], v[8:11], v[248:251], v[16:19]
    s_cbranch_vccnz L_s66
    s_bitcmp1_b32 s52, 1
    s_waitcnt vmcnt(7)
    s_cbranch_scc1 L_s66
    s_bitcmp1_b32 s52, 0
    s_waitcnt vmcnt(5)
    s_cbranch_scc1 L_s66
    s_waitcnt vmcnt(4)
L_s66:
    buffer_load_dwordx4 v[248:251], v1, s[32:35], s47 offen offset:2048 nt
    s_waitcnt vmcnt(31)
    v_mfma_f32_16x16x32_bf16 v[16:19], v[12:15], v[252:255], v[16:19]
    s_cbranch_vccnz L_s67
    s_bitcmp1_b32 s52, 1
    s_waitcnt vmcnt(7)
    s_cbranch_scc1 L_s67
    s_bitcmp1_b32 s52, 0
    s_waitcnt vmcnt(5)
    s_cbranch_scc1 L_s67
    s_waitcnt vmcnt(4)
L_s67:
    s_memrealtime s[54:55]
    buffer_load_dwordx4 v[252:255], v1, s[32:35], s47 offen offset:3072 nt
    s_cbranch_vccz L_vloop
    s_mov_b32 exec_lo, 0xffffffff
    s_mov_b32 exec_hi, 0x0
    s_nop 3
    ds_write_b128 v3, v[16:19] offset:2048
    s_mov_b64 exec, 1
    s_waitcnt lgkmcnt(0)
    ds_add_u32 v30, v31 offset:4160
    s_endpgm
.section .rodata,"a"
.p2align 6
.amdhsa_kernel recurrent_scan__mha_block_cached__glu_gated_bilinear__decode_kernel
  .amdhsa_next_free_vgpr 256
  .amdhsa_next_free_sgpr 102
  .amdhsa_accum_offset 256
  .amdhsa_group_segment_fixed_size 0
  .amdhsa_kernarg_size 96
  .amdhsa_user_sgpr_count 2
  .amdhsa_user_sgpr_kernarg_segment_ptr 1
  .amdhsa_system_sgpr_workgroup_id_x 1
  .amdhsa_float_denorm_mode_32 3
.end_amdhsa_kernel
```
